```python
import torch

def _softmax(x, axis=-1):
    return torch.softmax(x, dim=axis)
def _gelu(x):
    return torch.nn.functional.gelu(x, approximate="tanh")
def _silu(x):
    return torch.nn.functional.silu(x)
def _sigmoid(x):
    return torch.sigmoid(x)
def _layernorm(x, axis=-1, eps=1e-5):
    m = x.mean(dim=axis, keepdim=True)
    v = x.var(dim=axis, keepdim=True, unbiased=False)
    return (x - m) / torch.sqrt(v + eps)
def _scatter_add(tgt, idx, src, axis=0):
    return tgt.clone().index_add_(axis, idx, src)
def _segment_sum(src, seg, n):
    out = torch.zeros((n,) + src.shape[1:], dtype=src.dtype)
    return out.index_add_(0, seg, src)
def _pad(x, pw):
    flat = tuple(v for pair in reversed(pw) for v in pair)
    return torch.nn.functional.pad(x, flat)

kernel_name = 'parallel_sum__sliding_block_cached__mixer_token_mlp__decode'

def setup_inputs():

    _w = (lambda a: (lambda t: t.to(torch.bfloat16) if t.is_floating_point() else t)(torch.as_tensor(a)))
    def _A_setup():
        B, Sq, D = 1, 1, 448
        Hq, Hkv, Sk, Dh = 16, 8, 32768, 256
        assert Hq % Hkv == 0, (Hq, Hkv)
        return {
            "x": _w((lambda *s: torch.randn(*s, dtype=torch.bfloat16) * 0.05)(B, Sq, D)),
            "k_cache": _w((lambda *s: torch.randn(*s, dtype=torch.bfloat16) * 1.6)(B, Hkv, Sk, Dh)),
            "v_cache": _w((lambda *s: torch.randn(*s, dtype=torch.bfloat16) * 0.8)(B, Hkv, Sk, Dh)),
            "wq": _w((lambda *s: torch.randn(*s, dtype=torch.bfloat16) * 1.6)(D, Hq * Dh) * (D ** -0.5)),
            "wo": _w((lambda *s: torch.randn(*s, dtype=torch.bfloat16) * 0.8)(Hq * Dh, D) * ((Hq * Dh) ** -0.5)),
        }
    _A_in = _A_setup()

    def _B_setup():
        B, S, D, F = 1, 1, 448, 1792
        return {
            "x": _w((lambda *s: torch.randn(*s, dtype=torch.bfloat16) * 0.05)(B, S, D)),
            "w1": _w((lambda *s: torch.randn(*s, dtype=torch.bfloat16) * 0.4)(S, F) * (S ** -0.5)),
            "b1": _w((lambda *s: torch.randn(*s, dtype=torch.bfloat16) * 0.4)(F) * 0.02),
            "w2": _w((lambda *s: torch.randn(*s, dtype=torch.bfloat16) * 0.4)(F, S) * (F ** -0.5)),
            "b2": _w((lambda *s: torch.randn(*s, dtype=torch.bfloat16) * 0.4)(S) * 0.02),
        }
    _B_in = _B_setup()

    return {
        "A_x": _A_in["x"],
        "A_k_cache": _A_in["k_cache"],
        "A_v_cache": _A_in["v_cache"],
        "A_wq": _A_in["wq"],
        "A_wo": _A_in["wo"],
        "B_x": _B_in["x"],
        "B_w1": _B_in["w1"],
        "B_b1": _B_in["b1"],
        "B_w2": _B_in["w2"],
        "B_b2": _B_in["b2"],
    }

def reference(A_x, A_k_cache, A_v_cache, A_wq, A_wo, B_x, B_w1, B_b1, B_w2, B_b2):
    def _A_ref(x, k_cache, v_cache, wq, wo):
        B, Sq, D = x.shape
        Hq, Dh = 16, 256
        Hkv, Sk = k_cache.shape[1], k_cache.shape[2]
        W = min(4096, max(256, Sk // 4))
        rep = Hq // Hkv
        q = (lambda x, *d: x.permute(*d))((x @ wq).reshape(B, Sq, Hq, Dh), 0, 2, 1, 3)
        k = (lambda x, n, axis: torch.repeat_interleave(x, n, dim=axis))(k_cache[:, :, Sk - W:, :], rep, axis=1)
        v = (lambda x, n, axis: torch.repeat_interleave(x, n, dim=axis))(v_cache[:, :, Sk - W:, :], rep, axis=1)
        scores = torch.einsum("bhqd,bhkd->bhqk", q, k) * (Dh ** -0.5)
        p = _softmax(scores, axis=-1)
        o = torch.einsum("bhqk,bhkd->bhqd", p, v)
        return (lambda x, *d: x.permute(*d))(o, 0, 2, 1, 3).reshape(B, Sq, Hq * Dh) @ wo

    def _B_ref(x, w1, b1, w2, b2):
        B, S, D = x.shape
        h = _layernorm(x, axis=-1)
        u = torch.einsum("bsd,sf->bdf", h, w1) + b1
        u = _gelu(u)
        y = torch.einsum("bdf,fs->bds", u, w2) + b2
        return (lambda x, *d: x.permute(*d))(y, 0, 2, 1)

    x = A_x
    xn = _layernorm(x, axis=-1)
    return x + _A_ref(xn, A_k_cache, A_v_cache, A_wq, A_wo) + _B_ref(xn, B_w1, B_b1, B_w2, B_b2)
```

```asm
; @launch kernel=k1_kernel grid=(240,1,1) block=(256,1,1) lds=4096
; @launch kernel=k2_kernel grid=(256,1,1) block=(256,1,1) lds=20480
; @launch kernel=k3_kernel grid=(128,1,1) block=(256,1,1) lds=10240
; @launch kernel=k4_kernel grid=(7,1,1) block=(256,1,1) lds=2048
.amdgcn_target "amdgcn-amd-amdhsa--gfx950"
.text
.globl k1_kernel
.p2align 8
.type k1_kernel,@function
k1_kernel:
    s_cmp_ge_u32 s2, 240
    s_cbranch_scc1 K1_END
    s_load_dwordx2 s[4:5], s[0:1], 0
    s_load_dwordx2 s[6:7], s[0:1], 24
    s_load_dwordx2 s[8:9], s[0:1], 96
    s_load_dwordx2 s[10:11], s[0:1], 48
    s_load_dwordx2 s[12:13], s[0:1], 56
    s_load_dwordx2 s[14:15], s[0:1], 64
    s_load_dwordx2 s[16:17], s[0:1], 72
    v_and_b32 v1, 63, v0
    v_lshrrev_b32 v2, 6, v0
    s_nop 0
    v_readfirstlane_b32 s3, v2
    s_waitcnt lgkmcnt(0)
    s_mov_b32 s20, s4
    s_and_b32 s21, s5, 0xffff
    s_mov_b32 s22, 896
    s_mov_b32 s23, 0x00020000
    s_mov_b32 s24, s8
    s_and_b32 s25, s9, 0xffff
    s_mov_b32 s26, 536870912
    s_mov_b32 s27, 0x00020000
    v_lshlrev_b32 v3, 1, v1
    buffer_load_ushort v10, v3, s[20:23], 0 offen offset:0
    buffer_load_ushort v11, v3, s[20:23], 0 offen offset:128
    buffer_load_ushort v12, v3, s[20:23], 0 offen offset:256
    buffer_load_ushort v13, v3, s[20:23], 0 offen offset:384
    buffer_load_ushort v14, v3, s[20:23], 0 offen offset:512
    buffer_load_ushort v15, v3, s[20:23], 0 offen offset:640
    buffer_load_ushort v16, v3, s[20:23], 0 offen offset:768
    s_cmp_ge_u32 s2, 128
    s_cbranch_scc1 K1_MLP
    s_mov_b32 s28, s6
    s_and_b32 s29, s7, 0xffff
    s_mov_b32 s30, 3670016
    s_mov_b32 s31, 0x00020000
    v_lshrrev_b32 v4, 2, v1
    s_lshl_b32 s18, s3, 4
    v_add_u32 v4, s18, v4
    v_lshlrev_b32 v5, 1, v4
    buffer_load_ushort v20, v5, s[20:23], 0 offen offset:0
    buffer_load_ushort v21, v5, s[20:23], 0 offen offset:128
    buffer_load_ushort v22, v5, s[20:23], 0 offen offset:256
    buffer_load_ushort v23, v5, s[20:23], 0 offen offset:384
    buffer_load_ushort v24, v5, s[20:23], 0 offen offset:512
    buffer_load_ushort v25, v5, s[20:23], 0 offen offset:640
    buffer_load_ushort v26, v5, s[20:23], 0 offen offset:768
    v_and_b32 v6, 3, v1
    v_lshlrev_b32 v6, 4, v6
    v_lshl_add_u32 v6, v4, 13, v6
    s_lshl_b32 s18, s2, 6
    v_add_u32 v6, s18, v6
    s_mov_b32 s19, 0
    buffer_load_dwordx4 v[32:35], v6, s[28:31], s19 offen
    s_mov_b32 s19, 524288
    buffer_load_dwordx4 v[36:39], v6, s[28:31], s19 offen
    s_mov_b32 s19, 1048576
    buffer_load_dwordx4 v[40:43], v6, s[28:31], s19 offen
    s_mov_b32 s19, 1572864
    buffer_load_dwordx4 v[44:47], v6, s[28:31], s19 offen
    s_mov_b32 s19, 2097152
    buffer_load_dwordx4 v[48:51], v6, s[28:31], s19 offen
    s_mov_b32 s19, 2621440
    buffer_load_dwordx4 v[52:55], v6, s[28:31], s19 offen
    s_mov_b32 s19, 3145728
    buffer_load_dwordx4 v[56:59], v6, s[28:31], s19 offen
    s_waitcnt vmcnt(14)
    v_lshlrev_b32 v10, 16, v10
    v_lshlrev_b32 v11, 16, v11
    v_lshlrev_b32 v12, 16, v12
    v_lshlrev_b32 v13, 16, v13
    v_lshlrev_b32 v14, 16, v14
    v_lshlrev_b32 v15, 16, v15
    v_lshlrev_b32 v16, 16, v16
    v_add_f32 v60, v10, v11
    v_add_f32 v60, v60, v12
    v_add_f32 v60, v60, v13
    v_add_f32 v60, v60, v14
    v_add_f32 v60, v60, v15
    v_add_f32 v60, v60, v16
    s_nop 1
    v_add_f32_dpp v60, v60, v60 row_ror:8 row_mask:0xf bank_mask:0xf
    s_nop 1
    v_add_f32_dpp v60, v60, v60 row_ror:4 row_mask:0xf bank_mask:0xf
    s_nop 1
    v_add_f32_dpp v60, v60, v60 row_ror:2 row_mask:0xf bank_mask:0xf
    s_nop 1
    v_add_f32_dpp v60, v60, v60 row_ror:1 row_mask:0xf bank_mask:0xf
    s_nop 1
    v_readlane_b32 s40, v60, 0
    v_readlane_b32 s41, v60, 16
    v_readlane_b32 s42, v60, 32
    v_readlane_b32 s43, v60, 48
    s_nop 1
    v_mov_b32 v7, s40
    v_add_f32 v7, s41, v7
    v_add_f32 v7, s42, v7
    v_add_f32 v7, s43, v7
    v_mul_f32 v7, 0x3b124925, v7
    v_sub_f32 v61, v10, v7
    v_mul_f32 v60, v61, v61
    v_sub_f32 v61, v11, v7
    v_fmac_f32 v60, v61, v61
    v_sub_f32 v61, v12, v7
    v_fmac_f32 v60, v61, v61
    v_sub_f32 v61, v13, v7
    v_fmac_f32 v60, v61, v61
    v_sub_f32 v61, v14, v7
    v_fmac_f32 v60, v61, v61
    v_sub_f32 v61, v15, v7
    v_fmac_f32 v60, v61, v61
    v_sub_f32 v61, v16, v7
    v_fmac_f32 v60, v61, v61
    s_nop 1
    v_add_f32_dpp v60, v60, v60 row_ror:8 row_mask:0xf bank_mask:0xf
    s_nop 1
    v_add_f32_dpp v60, v60, v60 row_ror:4 row_mask:0xf bank_mask:0xf
    s_nop 1
    v_add_f32_dpp v60, v60, v60 row_ror:2 row_mask:0xf bank_mask:0xf
    s_nop 1
    v_add_f32_dpp v60, v60, v60 row_ror:1 row_mask:0xf bank_mask:0xf
    s_nop 1
    v_readlane_b32 s40, v60, 0
    v_readlane_b32 s41, v60, 16
    v_readlane_b32 s42, v60, 32
    v_readlane_b32 s43, v60, 48
    s_nop 1
    v_mov_b32 v8, s40
    v_add_f32 v8, s41, v8
    v_add_f32 v8, s42, v8
    v_add_f32 v8, s43, v8
    v_mul_f32 v8, 0x3b124925, v8
    v_cvt_pk_bf16_f32 v8, v8, v8
    v_and_b32 v8, 0xffff0000, v8
    v_add_f32 v8, 0x3727c5ac, v8
    v_cvt_pk_bf16_f32 v8, v8, v8
    v_and_b32 v8, 0xffff0000, v8
    v_sqrt_f32 v8, v8
    s_nop 0
    v_cvt_pk_bf16_f32 v8, v8, v8
    v_and_b32 v8, 0xffff0000, v8
    v_cvt_pk_bf16_f32 v7, v7, v7
    v_and_b32 v7, 0xffff0000, v7
    s_waitcnt vmcnt(7)
    v_lshlrev_b32 v20, 16, v20
    v_sub_f32 v20, v20, v7
    v_cvt_pk_bf16_f32 v20, v20, v20
    v_and_b32 v20, 0xffff0000, v20
    v_rcp_f32 v60, v8
    s_nop 0
    v_mul_f32 v61, v20, v60
    v_fma_f32 v20, -v61, v8, v20
    v_fma_f32 v20, v20, v60, v61
    v_cvt_pk_bf16_f32 v20, v20, v20
    v_and_b32 v20, 0xffff0000, v20
    v_lshlrev_b32 v21, 16, v21
    v_sub_f32 v21, v21, v7
    v_cvt_pk_bf16_f32 v21, v21, v21
    v_and_b32 v21, 0xffff0000, v21
    v_rcp_f32 v60, v8
    s_nop 0
    v_mul_f32 v61, v21, v60
    v_fma_f32 v21, -v61, v8, v21
    v_fma_f32 v21, v21, v60, v61
    v_cvt_pk_bf16_f32 v21, v21, v21
    v_and_b32 v21, 0xffff0000, v21
    v_lshlrev_b32 v22, 16, v22
    v_sub_f32 v22, v22, v7
    v_cvt_pk_bf16_f32 v22, v22, v22
    v_and_b32 v22, 0xffff0000, v22
    v_rcp_f32 v60, v8
    s_nop 0
    v_mul_f32 v61, v22, v60
    v_fma_f32 v22, -v61, v8, v22
    v_fma_f32 v22, v22, v60, v61
    v_cvt_pk_bf16_f32 v22, v22, v22
    v_and_b32 v22, 0xffff0000, v22
    v_lshlrev_b32 v23, 16, v23
    v_sub_f32 v23, v23, v7
    v_cvt_pk_bf16_f32 v23, v23, v23
    v_and_b32 v23, 0xffff0000, v23
    v_rcp_f32 v60, v8
    s_nop 0
    v_mul_f32 v61, v23, v60
    v_fma_f32 v23, -v61, v8, v23
    v_fma_f32 v23, v23, v60, v61
    v_cvt_pk_bf16_f32 v23, v23, v23
    v_and_b32 v23, 0xffff0000, v23
    v_lshlrev_b32 v24, 16, v24
    v_sub_f32 v24, v24, v7
    v_cvt_pk_bf16_f32 v24, v24, v24
    v_and_b32 v24, 0xffff0000, v24
    v_rcp_f32 v60, v8
    s_nop 0
    v_mul_f32 v61, v24, v60
    v_fma_f32 v24, -v61, v8, v24
    v_fma_f32 v24, v24, v60, v61
    v_cvt_pk_bf16_f32 v24, v24, v24
    v_and_b32 v24, 0xffff0000, v24
    v_lshlrev_b32 v25, 16, v25
    v_sub_f32 v25, v25, v7
    v_cvt_pk_bf16_f32 v25, v25, v25
    v_and_b32 v25, 0xffff0000, v25
    v_rcp_f32 v60, v8
    s_nop 0
    v_mul_f32 v61, v25, v60
    v_fma_f32 v25, -v61, v8, v25
    v_fma_f32 v25, v25, v60, v61
    v_cvt_pk_bf16_f32 v25, v25, v25
    v_and_b32 v25, 0xffff0000, v25
    v_lshlrev_b32 v26, 16, v26
    v_sub_f32 v26, v26, v7
    v_cvt_pk_bf16_f32 v26, v26, v26
    v_and_b32 v26, 0xffff0000, v26
    v_rcp_f32 v60, v8
    s_nop 0
    v_mul_f32 v61, v26, v60
    v_fma_f32 v26, -v61, v8, v26
    v_fma_f32 v26, v26, v60, v61
    v_cvt_pk_bf16_f32 v26, v26, v26
    v_and_b32 v26, 0xffff0000, v26
    v_mov_b32 v64, 0
    v_mov_b32 v65, 0
    v_mov_b32 v66, 0
    v_mov_b32 v67, 0
    v_mov_b32 v68, 0
    v_mov_b32 v69, 0
    v_mov_b32 v70, 0
    v_mov_b32 v71, 0
    s_waitcnt vmcnt(6)
    v_lshlrev_b32 v60, 16, v32
    v_and_b32 v61, 0xffff0000, v32
    v_fmac_f32 v64, v20, v60
    v_fmac_f32 v65, v20, v61
    v_lshlrev_b32 v60, 16, v33
    v_and_b32 v61, 0xffff0000, v33
    v_fmac_f32 v66, v20, v60
    v_fmac_f32 v67, v20, v61
    v_lshlrev_b32 v60, 16, v34
    v_and_b32 v61, 0xffff0000, v34
    v_fmac_f32 v68, v20, v60
    v_fmac_f32 v69, v20, v61
    v_lshlrev_b32 v60, 16, v35
    v_and_b32 v61, 0xffff0000, v35
    v_fmac_f32 v70, v20, v60
    v_fmac_f32 v71, v20, v61
    s_waitcnt vmcnt(5)
    v_lshlrev_b32 v60, 16, v36
    v_and_b32 v61, 0xffff0000, v36
    v_fmac_f32 v64, v21, v60
    v_fmac_f32 v65, v21, v61
    v_lshlrev_b32 v60, 16, v37
    v_and_b32 v61, 0xffff0000, v37
    v_fmac_f32 v66, v21, v60
    v_fmac_f32 v67, v21, v61
    v_lshlrev_b32 v60, 16, v38
    v_and_b32 v61, 0xffff0000, v38
    v_fmac_f32 v68, v21, v60
    v_fmac_f32 v69, v21, v61
    v_lshlrev_b32 v60, 16, v39
    v_and_b32 v61, 0xffff0000, v39
    v_fmac_f32 v70, v21, v60
    v_fmac_f32 v71, v21, v61
    s_waitcnt vmcnt(4)
    v_lshlrev_b32 v60, 16, v40
    v_and_b32 v61, 0xffff0000, v40
    v_fmac_f32 v64, v22, v60
    v_fmac_f32 v65, v22, v61
    v_lshlrev_b32 v60, 16, v41
    v_and_b32 v61, 0xffff0000, v41
    v_fmac_f32 v66, v22, v60
    v_fmac_f32 v67, v22, v61
    v_lshlrev_b32 v60, 16, v42
    v_and_b32 v61, 0xffff0000, v42
    v_fmac_f32 v68, v22, v60
    v_fmac_f32 v69, v22, v61
    v_lshlrev_b32 v60, 16, v43
    v_and_b32 v61, 0xffff0000, v43
    v_fmac_f32 v70, v22, v60
    v_fmac_f32 v71, v22, v61
    s_waitcnt vmcnt(3)
    v_lshlrev_b32 v60, 16, v44
    v_and_b32 v61, 0xffff0000, v44
    v_fmac_f32 v64, v23, v60
    v_fmac_f32 v65, v23, v61
    v_lshlrev_b32 v60, 16, v45
    v_and_b32 v61, 0xffff0000, v45
    v_fmac_f32 v66, v23, v60
    v_fmac_f32 v67, v23, v61
    v_lshlrev_b32 v60, 16, v46
    v_and_b32 v61, 0xffff0000, v46
    v_fmac_f32 v68, v23, v60
    v_fmac_f32 v69, v23, v61
    v_lshlrev_b32 v60, 16, v47
    v_and_b32 v61, 0xffff0000, v47
    v_fmac_f32 v70, v23, v60
    v_fmac_f32 v71, v23, v61
    s_waitcnt vmcnt(2)
    v_lshlrev_b32 v60, 16, v48
    v_and_b32 v61, 0xffff0000, v48
    v_fmac_f32 v64, v24, v60
    v_fmac_f32 v65, v24, v61
    v_lshlrev_b32 v60, 16, v49
    v_and_b32 v61, 0xffff0000, v49
    v_fmac_f32 v66, v24, v60
    v_fmac_f32 v67, v24, v61
    v_lshlrev_b32 v60, 16, v50
    v_and_b32 v61, 0xffff0000, v50
    v_fmac_f32 v68, v24, v60
    v_fmac_f32 v69, v24, v61
    v_lshlrev_b32 v60, 16, v51
    v_and_b32 v61, 0xffff0000, v51
    v_fmac_f32 v70, v24, v60
    v_fmac_f32 v71, v24, v61
    s_waitcnt vmcnt(1)
    v_lshlrev_b32 v60, 16, v52
    v_and_b32 v61, 0xffff0000, v52
    v_fmac_f32 v64, v25, v60
    v_fmac_f32 v65, v25, v61
    v_lshlrev_b32 v60, 16, v53
    v_and_b32 v61, 0xffff0000, v53
    v_fmac_f32 v66, v25, v60
    v_fmac_f32 v67, v25, v61
    v_lshlrev_b32 v60, 16, v54
    v_and_b32 v61, 0xffff0000, v54
    v_fmac_f32 v68, v25, v60
    v_fmac_f32 v69, v25, v61
    v_lshlrev_b32 v60, 16, v55
    v_and_b32 v61, 0xffff0000, v55
    v_fmac_f32 v70, v25, v60
    v_fmac_f32 v71, v25, v61
    s_waitcnt vmcnt(0)
    v_lshlrev_b32 v60, 16, v56
    v_and_b32 v61, 0xffff0000, v56
    v_fmac_f32 v64, v26, v60
    v_fmac_f32 v65, v26, v61
    v_lshlrev_b32 v60, 16, v57
    v_and_b32 v61, 0xffff0000, v57
    v_fmac_f32 v66, v26, v60
    v_fmac_f32 v67, v26, v61
    v_lshlrev_b32 v60, 16, v58
    v_and_b32 v61, 0xffff0000, v58
    v_fmac_f32 v68, v26, v60
    v_fmac_f32 v69, v26, v61
    v_lshlrev_b32 v60, 16, v59
    v_and_b32 v61, 0xffff0000, v59
    v_fmac_f32 v70, v26, v60
    v_fmac_f32 v71, v26, v61
    s_nop 1
    v_add_f32_dpp v64, v64, v64 row_ror:4 row_mask:0xf bank_mask:0xf
    s_nop 1
    v_add_f32_dpp v64, v64, v64 row_ror:8 row_mask:0xf bank_mask:0xf
    s_nop 1
    v_add_f32_dpp v65, v65, v65 row_ror:4 row_mask:0xf bank_mask:0xf
    s_nop 1
    v_add_f32_dpp v65, v65, v65 row_ror:8 row_mask:0xf bank_mask:0xf
    s_nop 1
    v_add_f32_dpp v66, v66, v66 row_ror:4 row_mask:0xf bank_mask:0xf
    s_nop 1
    v_add_f32_dpp v66, v66, v66 row_ror:8 row_mask:0xf bank_mask:0xf
    s_nop 1
    v_add_f32_dpp v67, v67, v67 row_ror:4 row_mask:0xf bank_mask:0xf
    s_nop 1
    v_add_f32_dpp v67, v67, v67 row_ror:8 row_mask:0xf bank_mask:0xf
    s_nop 1
    v_add_f32_dpp v68, v68, v68 row_ror:4 row_mask:0xf bank_mask:0xf
    s_nop 1
    v_add_f32_dpp v68, v68, v68 row_ror:8 row_mask:0xf bank_mask:0xf
    s_nop 1
    v_add_f32_dpp v69, v69, v69 row_ror:4 row_mask:0xf bank_mask:0xf
    s_nop 1
    v_add_f32_dpp v69, v69, v69 row_ror:8 row_mask:0xf bank_mask:0xf
    s_nop 1
    v_add_f32_dpp v70, v70, v70 row_ror:4 row_mask:0xf bank_mask:0xf
    s_nop 1
    v_add_f32_dpp v70, v70, v70 row_ror:8 row_mask:0xf bank_mask:0xf
    s_nop 1
    v_add_f32_dpp v71, v71, v71 row_ror:4 row_mask:0xf bank_mask:0xf
    s_nop 1
    v_add_f32_dpp v71, v71, v71 row_ror:8 row_mask:0xf bank_mask:0xf
    v_lshrrev_b32 v9, 4, v1
    s_lshl_b32 s18, s3, 2
    v_add_u32 v9, s18, v9
    v_lshlrev_b32 v9, 7, v9
    v_and_b32 v60, 3, v1
    v_lshl_add_u32 v9, v60, 5, v9
    v_and_b32 v60, 15, v1
    v_cmp_gt_u32 vcc, 4, v60
    s_and_saveexec_b64 s[36:37], vcc
    ds_write_b128 v9, v[64:67]
    ds_write_b128 v9, v[68:71] offset:16
    s_mov_b64 exec, s[36:37]
    s_waitcnt lgkmcnt(0)
    s_barrier
    v_cmp_gt_u32 vcc, 32, v0
    s_and_saveexec_b64 s[36:37], vcc
    s_cbranch_execz K1_QDONE
    v_lshlrev_b32 v9, 2, v0
    ds_read_b32 v80, v9 offset:0
    ds_read_b32 v81, v9 offset:128
    ds_read_b32 v82, v9 offset:256
    ds_read_b32 v83, v9 offset:384
    ds_read_b32 v84, v9 offset:512
    ds_read_b32 v85, v9 offset:640
    ds_read_b32 v86, v9 offset:768
    ds_read_b32 v87, v9 offset:896
    ds_read_b32 v88, v9 offset:1024
    ds_read_b32 v89, v9 offset:1152
    ds_read_b32 v90, v9 offset:1280
    ds_read_b32 v91, v9 offset:1408
    ds_read_b32 v92, v9 offset:1536
    ds_read_b32 v93, v9 offset:1664
    ds_read_b32 v94, v9 offset:1792
    ds_read_b32 v95, v9 offset:1920
    s_waitcnt lgkmcnt(0)
    v_add_f32 v80, v80, v81
    v_add_f32 v80, v80, v82
    v_add_f32 v80, v80, v83
    v_add_f32 v80, v80, v84
    v_add_f32 v80, v80, v85
    v_add_f32 v80, v80, v86
    v_add_f32 v80, v80, v87
    v_add_f32 v80, v80, v88
    v_add_f32 v80, v80, v89
    v_add_f32 v80, v80, v90
    v_add_f32 v80, v80, v91
    v_add_f32 v80, v80, v92
    v_add_f32 v80, v80, v93
    v_add_f32 v80, v80, v94
    v_add_f32 v80, v80, v95
    v_cvt_pk_bf16_f32 v80, v80, v80
    v_lshlrev_b32 v9, 1, v0
    s_lshl_b32 s18, s2, 6
    v_add_u32 v9, s18, v9
    buffer_store_short v80, v9, s[24:27], 0 offen offset:0
K1_QDONE:
    s_mov_b64 exec, s[36:37]
    s_branch K1_END
K1_MLP:
    s_mov_b32 s28, s10
    s_and_b32 s29, s11, 0xffff
    s_mov_b32 s30, 3584
    s_mov_b32 s31, 0x00020000
    s_mov_b32 s32, s12
    s_and_b32 s33, s13, 0xffff
    s_mov_b32 s34, 3584
    s_mov_b32 s35, 0x00020000
    s_mov_b32 s36, s14
    s_and_b32 s37, s15, 0xffff
    s_mov_b32 s38, 3584
    s_mov_b32 s39, 0x00020000
    s_sub_u32 s18, s2, 128
    s_lshl_b32 s18, s18, 2
    s_add_u32 s18, s18, s3
    s_lshl_b32 s19, s18, 1
    v_mov_b32 v4, s19
    buffer_load_ushort v20, v4, s[20:23], 0 offen
    v_lshlrev_b32 v5, 3, v1
    buffer_load_dwordx2 v[32:33], v5, s[28:31], 0 offen offset:0
    buffer_load_dwordx2 v[48:49], v5, s[32:35], 0 offen offset:0
    buffer_load_dwordx2 v[64:65], v5, s[36:39], 0 offen offset:0
    buffer_load_dwordx2 v[34:35], v5, s[28:31], 0 offen offset:512
    buffer_load_dwordx2 v[50:51], v5, s[32:35], 0 offen offset:512
    buffer_load_dwordx2 v[66:67], v5, s[36:39], 0 offen offset:512
    buffer_load_dwordx2 v[36:37], v5, s[28:31], 0 offen offset:1024
    buffer_load_dwordx2 v[52:53], v5, s[32:35], 0 offen offset:1024
    buffer_load_dwordx2 v[68:69], v5, s[36:39], 0 offen offset:1024
    buffer_load_dwordx2 v[38:39], v5, s[28:31], 0 offen offset:1536
    buffer_load_dwordx2 v[54:55], v5, s[32:35], 0 offen offset:1536
    buffer_load_dwordx2 v[70:71], v5, s[36:39], 0 offen offset:1536
    buffer_load_dwordx2 v[40:41], v5, s[28:31], 0 offen offset:2048
    buffer_load_dwordx2 v[56:57], v5, s[32:35], 0 offen offset:2048
    buffer_load_dwordx2 v[72:73], v5, s[36:39], 0 offen offset:2048
    buffer_load_dwordx2 v[42:43], v5, s[28:31], 0 offen offset:2560
    buffer_load_dwordx2 v[58:59], v5, s[32:35], 0 offen offset:2560
    buffer_load_dwordx2 v[74:75], v5, s[36:39], 0 offen offset:2560
    buffer_load_dwordx2 v[44:45], v5, s[28:31], 0 offen offset:3072
    buffer_load_dwordx2 v[60:61], v5, s[32:35], 0 offen offset:3072
    buffer_load_dwordx2 v[76:77], v5, s[36:39], 0 offen offset:3072
    s_load_dword s44, s[16:17], 0
    s_waitcnt vmcnt(22)
    v_lshlrev_b32 v10, 16, v10
    v_lshlrev_b32 v11, 16, v11
    v_lshlrev_b32 v12, 16, v12
    v_lshlrev_b32 v13, 16, v13
    v_lshlrev_b32 v14, 16, v14
    v_lshlrev_b32 v15, 16, v15
    v_lshlrev_b32 v16, 16, v16
    v_add_f32 v80, v10, v11
    v_add_f32 v80, v80, v12
    v_add_f32 v80, v80, v13
    v_add_f32 v80, v80, v14
    v_add_f32 v80, v80, v15
    v_add_f32 v80, v80, v16
    s_nop 1
    v_add_f32_dpp v80, v80, v80 row_ror:8 row_mask:0xf bank_mask:0xf
    s_nop 1
    v_add_f32_dpp v80, v80, v80 row_ror:4 row_mask:0xf bank_mask:0xf
    s_nop 1
    v_add_f32_dpp v80, v80, v80 row_ror:2 row_mask:0xf bank_mask:0xf
    s_nop 1
    v_add_f32_dpp v80, v80, v80 row_ror:1 row_mask:0xf bank_mask:0xf
    s_nop 1
    v_readlane_b32 s40, v80, 0
    v_readlane_b32 s41, v80, 16
    v_readlane_b32 s42, v80, 32
    v_readlane_b32 s43, v80, 48
    s_nop 1
    v_mov_b32 v7, s40
    v_add_f32 v7, s41, v7
    v_add_f32 v7, s42, v7
    v_add_f32 v7, s43, v7
    v_mul_f32 v7, 0x3b124925, v7
    v_sub_f32 v81, v10, v7
    v_mul_f32 v80, v81, v81
    v_sub_f32 v81, v11, v7
    v_fmac_f32 v80, v81, v81
    v_sub_f32 v81, v12, v7
    v_fmac_f32 v80, v81, v81
    v_sub_f32 v81, v13, v7
    v_fmac_f32 v80, v81, v81
    v_sub_f32 v81, v14, v7
    v_fmac_f32 v80, v81, v81
    v_sub_f32 v81, v15, v7
    v_fmac_f32 v80, v81, v81
    v_sub_f32 v81, v16, v7
    v_fmac_f32 v80, v81, v81
    s_nop 1
    v_add_f32_dpp v80, v80, v80 row_ror:8 row_mask:0xf bank_mask:0xf
    s_nop 1
    v_add_f32_dpp v80, v80, v80 row_ror:4 row_mask:0xf bank_mask:0xf
    s_nop 1
    v_add_f32_dpp v80, v80, v80 row_ror:2 row_mask:0xf bank_mask:0xf
    s_nop 1
    v_add_f32_dpp v80, v80, v80 row_ror:1 row_mask:0xf bank_mask:0xf
    s_nop 1
    v_readlane_b32 s40, v80, 0
    v_readlane_b32 s41, v80, 16
    v_readlane_b32 s42, v80, 32
    v_readlane_b32 s43, v80, 48
    s_nop 1
    v_mov_b32 v8, s40
    v_add_f32 v8, s41, v8
    v_add_f32 v8, s42, v8
    v_add_f32 v8, s43, v8
    v_mul_f32 v8, 0x3b124925, v8
    v_cvt_pk_bf16_f32 v8, v8, v8
    v_and_b32 v8, 0xffff0000, v8
    v_add_f32 v8, 0x3727c5ac, v8
    v_cvt_pk_bf16_f32 v8, v8, v8
    v_and_b32 v8, 0xffff0000, v8
    v_sqrt_f32 v8, v8
    s_nop 0
    v_cvt_pk_bf16_f32 v8, v8, v8
    v_and_b32 v8, 0xffff0000, v8
    v_cvt_pk_bf16_f32 v7, v7, v7
    v_and_b32 v7, 0xffff0000, v7
    s_waitcnt vmcnt(21)
    v_lshlrev_b32 v20, 16, v20
    v_sub_f32 v10, v10, v7
    v_cvt_pk_bf16_f32 v10, v10, v10
    v_and_b32 v10, 0xffff0000, v10
    v_rcp_f32 v80, v8
    s_nop 0
    v_mul_f32 v81, v10, v80
    v_fma_f32 v10, -v81, v8, v10
    v_fma_f32 v10, v10, v80, v81
    v_cvt_pk_bf16_f32 v10, v10, v10
    v_and_b32 v10, 0xffff0000, v10
    v_sub_f32 v11, v11, v7
    v_cvt_pk_bf16_f32 v11, v11, v11
    v_and_b32 v11, 0xffff0000, v11
    v_rcp_f32 v80, v8
    s_nop 0
    v_mul_f32 v81, v11, v80
    v_fma_f32 v11, -v81, v8, v11
    v_fma_f32 v11, v11, v80, v81
    v_cvt_pk_bf16_f32 v11, v11, v11
    v_and_b32 v11, 0xffff0000, v11
    v_sub_f32 v12, v12, v7
    v_cvt_pk_bf16_f32 v12, v12, v12
    v_and_b32 v12, 0xffff0000, v12
    v_rcp_f32 v80, v8
    s_nop 0
    v_mul_f32 v81, v12, v80
    v_fma_f32 v12, -v81, v8, v12
    v_fma_f32 v12, v12, v80, v81
    v_cvt_pk_bf16_f32 v12, v12, v12
    v_and_b32 v12, 0xffff0000, v12
    v_sub_f32 v13, v13, v7
    v_cvt_pk_bf16_f32 v13, v13, v13
    v_and_b32 v13, 0xffff0000, v13
    v_rcp_f32 v80, v8
    s_nop 0
    v_mul_f32 v81, v13, v80
    v_fma_f32 v13, -v81, v8, v13
    v_fma_f32 v13, v13, v80, v81
    v_cvt_pk_bf16_f32 v13, v13, v13
    v_and_b32 v13, 0xffff0000, v13
    v_sub_f32 v14, v14, v7
    v_cvt_pk_bf16_f32 v14, v14, v14
    v_and_b32 v14, 0xffff0000, v14
    v_rcp_f32 v80, v8
    s_nop 0
    v_mul_f32 v81, v14, v80
    v_fma_f32 v14, -v81, v8, v14
    v_fma_f32 v14, v14, v80, v81
    v_cvt_pk_bf16_f32 v14, v14, v14
    v_and_b32 v14, 0xffff0000, v14
    v_sub_f32 v15, v15, v7
    v_cvt_pk_bf16_f32 v15, v15, v15
    v_and_b32 v15, 0xffff0000, v15
    v_rcp_f32 v80, v8
    s_nop 0
    v_mul_f32 v81, v15, v80
    v_fma_f32 v15, -v81, v8, v15
    v_fma_f32 v15, v15, v80, v81
    v_cvt_pk_bf16_f32 v15, v15, v15
    v_and_b32 v15, 0xffff0000, v15
    v_sub_f32 v16, v16, v7
    v_cvt_pk_bf16_f32 v16, v16, v16
    v_and_b32 v16, 0xffff0000, v16
    v_rcp_f32 v80, v8
    s_nop 0
    v_mul_f32 v81, v16, v80
    v_fma_f32 v16, -v81, v8, v16
    v_fma_f32 v16, v16, v80, v81
    v_cvt_pk_bf16_f32 v16, v16, v16
    v_and_b32 v16, 0xffff0000, v16
    v_sub_f32 v20, v20, v7
    v_cvt_pk_bf16_f32 v20, v20, v20
    v_and_b32 v20, 0xffff0000, v20
    v_rcp_f32 v80, v8
    s_nop 0
    v_mul_f32 v81, v20, v80
    v_fma_f32 v20, -v81, v8, v20
    v_fma_f32 v20, v20, v80, v81
    v_cvt_pk_bf16_f32 v20, v20, v20
    v_and_b32 v20, 0xffff0000, v20
    v_add_f32 v80, v10, v11
    v_add_f32 v80, v80, v12
    v_add_f32 v80, v80, v13
    v_add_f32 v80, v80, v14
    v_add_f32 v80, v80, v15
    v_add_f32 v80, v80, v16
    s_nop 1
    v_add_f32_dpp v80, v80, v80 row_ror:8 row_mask:0xf bank_mask:0xf
    s_nop 1
    v_add_f32_dpp v80, v80, v80 row_ror:4 row_mask:0xf bank_mask:0xf
    s_nop 1
    v_add_f32_dpp v80, v80, v80 row_ror:2 row_mask:0xf bank_mask:0xf
    s_nop 1
    v_add_f32_dpp v80, v80, v80 row_ror:1 row_mask:0xf bank_mask:0xf
    s_nop 1
    v_readlane_b32 s40, v80, 0
    v_readlane_b32 s41, v80, 16
    v_readlane_b32 s42, v80, 32
    v_readlane_b32 s43, v80, 48
    s_nop 1
    v_mov_b32 v7, s40
    v_add_f32 v7, s41, v7
    v_add_f32 v7, s42, v7
    v_add_f32 v7, s43, v7
    v_mul_f32 v7, 0x3b124925, v7
    v_sub_f32 v81, v10, v7
    v_mul_f32 v80, v81, v81
    v_sub_f32 v81, v11, v7
    v_fmac_f32 v80, v81, v81
    v_sub_f32 v81, v12, v7
    v_fmac_f32 v80, v81, v81
    v_sub_f32 v81, v13, v7
    v_fmac_f32 v80, v81, v81
    v_sub_f32 v81, v14, v7
    v_fmac_f32 v80, v81, v81
    v_sub_f32 v81, v15, v7
    v_fmac_f32 v80, v81, v81
    v_sub_f32 v81, v16, v7
    v_fmac_f32 v80, v81, v81
    s_nop 1
    v_add_f32_dpp v80, v80, v80 row_ror:8 row_mask:0xf bank_mask:0xf
    s_nop 1
    v_add_f32_dpp v80, v80, v80 row_ror:4 row_mask:0xf bank_mask:0xf
    s_nop 1
    v_add_f32_dpp v80, v80, v80 row_ror:2 row_mask:0xf bank_mask:0xf
    s_nop 1
    v_add_f32_dpp v80, v80, v80 row_ror:1 row_mask:0xf bank_mask:0xf
    s_nop 1
    v_readlane_b32 s40, v80, 0
    v_readlane_b32 s41, v80, 16
    v_readlane_b32 s42, v80, 32
    v_readlane_b32 s43, v80, 48
    s_nop 1
    v_mov_b32 v8, s40
    v_add_f32 v8, s41, v8
    v_add_f32 v8, s42, v8
    v_add_f32 v8, s43, v8
    v_mul_f32 v8, 0x3b124925, v8
    v_cvt_pk_bf16_f32 v8, v8, v8
    v_and_b32 v8, 0xffff0000, v8
    v_add_f32 v8, 0x3727c5ac, v8
    v_cvt_pk_bf16_f32 v8, v8, v8
    v_and_b32 v8, 0xffff0000, v8
    v_sqrt_f32 v8, v8
    s_nop 0
    v_cvt_pk_bf16_f32 v8, v8, v8
    v_and_b32 v8, 0xffff0000, v8
    v_cvt_pk_bf16_f32 v7, v7, v7
    v_and_b32 v7, 0xffff0000, v7
    v_sub_f32 v20, v20, v7
    v_cvt_pk_bf16_f32 v20, v20, v20
    v_and_b32 v20, 0xffff0000, v20
    v_rcp_f32 v80, v8
    s_nop 0
    v_mul_f32 v81, v20, v80
    v_fma_f32 v20, -v81, v8, v20
    v_fma_f32 v20, v20, v80, v81
    v_cvt_pk_bf16_f32 v20, v20, v20
    v_and_b32 v20, 0xffff0000, v20
    v_mov_b32 v21, 0
    s_waitcnt vmcnt(0)
    s_mov_b32 s45, 0x3d372713
    s_mov_b32 s46, 0xc0135761
    v_lshlrev_b32 v82, 16, v32
    v_lshlrev_b32 v83, 16, v48
    v_lshlrev_b32 v84, 16, v64
    v_mul_f32 v82, v20, v82
    v_cvt_pk_bf16_f32 v82, v82, v82
    v_and_b32 v82, 0xffff0000, v82
    v_add_f32 v82, v82, v83
    v_cvt_pk_bf16_f32 v82, v82, v82
    v_and_b32 v82, 0xffff0000, v82
    v_mul_f32 v83, v82, v82
    v_mul_f32 v83, s45, v83
    v_fma_f32 v83, v83, v82, v82
    v_mul_f32 v83, s46, v83
    v_exp_f32 v83, v83
    s_nop 0
    v_add_f32 v83, 1.0, v83
    v_rcp_f32 v83, v83
    s_nop 0
    v_mul_f32 v82, v82, v83
    v_cvt_pk_bf16_f32 v82, v82, v82
    v_and_b32 v82, 0xffff0000, v82
    v_fmac_f32 v21, v82, v84
    v_and_b32 v82, 0xffff0000, v32
    v_and_b32 v83, 0xffff0000, v48
    v_and_b32 v84, 0xffff0000, v64
    v_mul_f32 v82, v20, v82
    v_cvt_pk_bf16_f32 v82, v82, v82
    v_and_b32 v82, 0xffff0000, v82
    v_add_f32 v82, v82, v83
    v_cvt_pk_bf16_f32 v82, v82, v82
    v_and_b32 v82, 0xffff0000, v82
    v_mul_f32 v83, v82, v82
    v_mul_f32 v83, s45, v83
    v_fma_f32 v83, v83, v82, v82
    v_mul_f32 v83, s46, v83
    v_exp_f32 v83, v83
    s_nop 0
    v_add_f32 v83, 1.0, v83
    v_rcp_f32 v83, v83
    s_nop 0
    v_mul_f32 v82, v82, v83
    v_cvt_pk_bf16_f32 v82, v82, v82
    v_and_b32 v82, 0xffff0000, v82
    v_fmac_f32 v21, v82, v84
    v_lshlrev_b32 v82, 16, v33
    v_lshlrev_b32 v83, 16, v49
    v_lshlrev_b32 v84, 16, v65
    v_mul_f32 v82, v20, v82
    v_cvt_pk_bf16_f32 v82, v82, v82
    v_and_b32 v82, 0xffff0000, v82
    v_add_f32 v82, v82, v83
    v_cvt_pk_bf16_f32 v82, v82, v82
    v_and_b32 v82, 0xffff0000, v82
    v_mul_f32 v83, v82, v82
    v_mul_f32 v83, s45, v83
    v_fma_f32 v83, v83, v82, v82
    v_mul_f32 v83, s46, v83
    v_exp_f32 v83, v83
    s_nop 0
    v_add_f32 v83, 1.0, v83
    v_rcp_f32 v83, v83
    s_nop 0
    v_mul_f32 v82, v82, v83
    v_cvt_pk_bf16_f32 v82, v82, v82
    v_and_b32 v82, 0xffff0000, v82
    v_fmac_f32 v21, v82, v84
    v_and_b32 v82, 0xffff0000, v33
    v_and_b32 v83, 0xffff0000, v49
    v_and_b32 v84, 0xffff0000, v65
    v_mul_f32 v82, v20, v82
    v_cvt_pk_bf16_f32 v82, v82, v82
    v_and_b32 v82, 0xffff0000, v82
    v_add_f32 v82, v82, v83
    v_cvt_pk_bf16_f32 v82, v82, v82
    v_and_b32 v82, 0xffff0000, v82
    v_mul_f32 v83, v82, v82
    v_mul_f32 v83, s45, v83
    v_fma_f32 v83, v83, v82, v82
    v_mul_f32 v83, s46, v83
    v_exp_f32 v83, v83
    s_nop 0
    v_add_f32 v83, 1.0, v83
    v_rcp_f32 v83, v83
    s_nop 0
    v_mul_f32 v82, v82, v83
    v_cvt_pk_bf16_f32 v82, v82, v82
    v_and_b32 v82, 0xffff0000, v82
    v_fmac_f32 v21, v82, v84
    v_lshlrev_b32 v82, 16, v34
    v_lshlrev_b32 v83, 16, v50
    v_lshlrev_b32 v84, 16, v66
    v_mul_f32 v82, v20, v82
    v_cvt_pk_bf16_f32 v82, v82, v82
    v_and_b32 v82, 0xffff0000, v82
    v_add_f32 v82, v82, v83
    v_cvt_pk_bf16_f32 v82, v82, v82
    v_and_b32 v82, 0xffff0000, v82
    v_mul_f32 v83, v82, v82
    v_mul_f32 v83, s45, v83
    v_fma_f32 v83, v83, v82, v82
    v_mul_f32 v83, s46, v83
    v_exp_f32 v83, v83
    s_nop 0
    v_add_f32 v83, 1.0, v83
    v_rcp_f32 v83, v83
    s_nop 0
    v_mul_f32 v82, v82, v83
    v_cvt_pk_bf16_f32 v82, v82, v82
    v_and_b32 v82, 0xffff0000, v82
    v_fmac_f32 v21, v82, v84
    v_and_b32 v82, 0xffff0000, v34
    v_and_b32 v83, 0xffff0000, v50
    v_and_b32 v84, 0xffff0000, v66
    v_mul_f32 v82, v20, v82
    v_cvt_pk_bf16_f32 v82, v82, v82
    v_and_b32 v82, 0xffff0000, v82
    v_add_f32 v82, v82, v83
    v_cvt_pk_bf16_f32 v82, v82, v82
    v_and_b32 v82, 0xffff0000, v82
    v_mul_f32 v83, v82, v82
    v_mul_f32 v83, s45, v83
    v_fma_f32 v83, v83, v82, v82
    v_mul_f32 v83, s46, v83
    v_exp_f32 v83, v83
    s_nop 0
    v_add_f32 v83, 1.0, v83
    v_rcp_f32 v83, v83
    s_nop 0
    v_mul_f32 v82, v82, v83
    v_cvt_pk_bf16_f32 v82, v82, v82
    v_and_b32 v82, 0xffff0000, v82
    v_fmac_f32 v21, v82, v84
    v_lshlrev_b32 v82, 16, v35
    v_lshlrev_b32 v83, 16, v51
    v_lshlrev_b32 v84, 16, v67
    v_mul_f32 v82, v20, v82
    v_cvt_pk_bf16_f32 v82, v82, v82
    v_and_b32 v82, 0xffff0000, v82
    v_add_f32 v82, v82, v83
    v_cvt_pk_bf16_f32 v82, v82, v82
    v_and_b32 v82, 0xffff0000, v82
    v_mul_f32 v83, v82, v82
    v_mul_f32 v83, s45, v83
    v_fma_f32 v83, v83, v82, v82
    v_mul_f32 v83, s46, v83
    v_exp_f32 v83, v83
    s_nop 0
    v_add_f32 v83, 1.0, v83
    v_rcp_f32 v83, v83
    s_nop 0
    v_mul_f32 v82, v82, v83
    v_cvt_pk_bf16_f32 v82, v82, v82
    v_and_b32 v82, 0xffff0000, v82
    v_fmac_f32 v21, v82, v84
    v_and_b32 v82, 0xffff0000, v35
    v_and_b32 v83, 0xffff0000, v51
    v_and_b32 v84, 0xffff0000, v67
    v_mul_f32 v82, v20, v82
    v_cvt_pk_bf16_f32 v82, v82, v82
    v_and_b32 v82, 0xffff0000, v82
    v_add_f32 v82, v82, v83
    v_cvt_pk_bf16_f32 v82, v82, v82
    v_and_b32 v82, 0xffff0000, v82
    v_mul_f32 v83, v82, v82
    v_mul_f32 v83, s45, v83
    v_fma_f32 v83, v83, v82, v82
    v_mul_f32 v83, s46, v83
    v_exp_f32 v83, v83
    s_nop 0
    v_add_f32 v83, 1.0, v83
    v_rcp_f32 v83, v83
    s_nop 0
    v_mul_f32 v82, v82, v83
    v_cvt_pk_bf16_f32 v82, v82, v82
    v_and_b32 v82, 0xffff0000, v82
    v_fmac_f32 v21, v82, v84
    v_lshlrev_b32 v82, 16, v36
    v_lshlrev_b32 v83, 16, v52
    v_lshlrev_b32 v84, 16, v68
    v_mul_f32 v82, v20, v82
    v_cvt_pk_bf16_f32 v82, v82, v82
    v_and_b32 v82, 0xffff0000, v82
    v_add_f32 v82, v82, v83
    v_cvt_pk_bf16_f32 v82, v82, v82
    v_and_b32 v82, 0xffff0000, v82
    v_mul_f32 v83, v82, v82
    v_mul_f32 v83, s45, v83
    v_fma_f32 v83, v83, v82, v82
    v_mul_f32 v83, s46, v83
    v_exp_f32 v83, v83
    s_nop 0
    v_add_f32 v83, 1.0, v83
    v_rcp_f32 v83, v83
    s_nop 0
    v_mul_f32 v82, v82, v83
    v_cvt_pk_bf16_f32 v82, v82, v82
    v_and_b32 v82, 0xffff0000, v82
    v_fmac_f32 v21, v82, v84
    v_and_b32 v82, 0xffff0000, v36
    v_and_b32 v83, 0xffff0000, v52
    v_and_b32 v84, 0xffff0000, v68
    v_mul_f32 v82, v20, v82
    v_cvt_pk_bf16_f32 v82, v82, v82
    v_and_b32 v82, 0xffff0000, v82
    v_add_f32 v82, v82, v83
    v_cvt_pk_bf16_f32 v82, v82, v82
    v_and_b32 v82, 0xffff0000, v82
    v_mul_f32 v83, v82, v82
    v_mul_f32 v83, s45, v83
    v_fma_f32 v83, v83, v82, v82
    v_mul_f32 v83, s46, v83
    v_exp_f32 v83, v83
    s_nop 0
    v_add_f32 v83, 1.0, v83
    v_rcp_f32 v83, v83
    s_nop 0
    v_mul_f32 v82, v82, v83
    v_cvt_pk_bf16_f32 v82, v82, v82
    v_and_b32 v82, 0xffff0000, v82
    v_fmac_f32 v21, v82, v84
    v_lshlrev_b32 v82, 16, v37
    v_lshlrev_b32 v83, 16, v53
    v_lshlrev_b32 v84, 16, v69
    v_mul_f32 v82, v20, v82
    v_cvt_pk_bf16_f32 v82, v82, v82
    v_and_b32 v82, 0xffff0000, v82
    v_add_f32 v82, v82, v83
    v_cvt_pk_bf16_f32 v82, v82, v82
    v_and_b32 v82, 0xffff0000, v82
    v_mul_f32 v83, v82, v82
    v_mul_f32 v83, s45, v83
    v_fma_f32 v83, v83, v82, v82
    v_mul_f32 v83, s46, v83
    v_exp_f32 v83, v83
    s_nop 0
    v_add_f32 v83, 1.0, v83
    v_rcp_f32 v83, v83
    s_nop 0
    v_mul_f32 v82, v82, v83
    v_cvt_pk_bf16_f32 v82, v82, v82
    v_and_b32 v82, 0xffff0000, v82
    v_fmac_f32 v21, v82, v84
    v_and_b32 v82, 0xffff0000, v37
    v_and_b32 v83, 0xffff0000, v53
    v_and_b32 v84, 0xffff0000, v69
    v_mul_f32 v82, v20, v82
    v_cvt_pk_bf16_f32 v82, v82, v82
    v_and_b32 v82, 0xffff0000, v82
    v_add_f32 v82, v82, v83
    v_cvt_pk_bf16_f32 v82, v82, v82
    v_and_b32 v82, 0xffff0000, v82
    v_mul_f32 v83, v82, v82
    v_mul_f32 v83, s45, v83
    v_fma_f32 v83, v83, v82, v82
    v_mul_f32 v83, s46, v83
    v_exp_f32 v83, v83
    s_nop 0
    v_add_f32 v83, 1.0, v83
    v_rcp_f32 v83, v83
    s_nop 0
    v_mul_f32 v82, v82, v83
    v_cvt_pk_bf16_f32 v82, v82, v82
    v_and_b32 v82, 0xffff0000, v82
    v_fmac_f32 v21, v82, v84
    v_lshlrev_b32 v82, 16, v38
    v_lshlrev_b32 v83, 16, v54
    v_lshlrev_b32 v84, 16, v70
    v_mul_f32 v82, v20, v82
    v_cvt_pk_bf16_f32 v82, v82, v82
    v_and_b32 v82, 0xffff0000, v82
    v_add_f32 v82, v82, v83
    v_cvt_pk_bf16_f32 v82, v82, v82
    v_and_b32 v82, 0xffff0000, v82
    v_mul_f32 v83, v82, v82
    v_mul_f32 v83, s45, v83
    v_fma_f32 v83, v83, v82, v82
    v_mul_f32 v83, s46, v83
    v_exp_f32 v83, v83
    s_nop 0
    v_add_f32 v83, 1.0, v83
    v_rcp_f32 v83, v83
    s_nop 0
    v_mul_f32 v82, v82, v83
    v_cvt_pk_bf16_f32 v82, v82, v82
    v_and_b32 v82, 0xffff0000, v82
    v_fmac_f32 v21, v82, v84
    v_and_b32 v82, 0xffff0000, v38
    v_and_b32 v83, 0xffff0000, v54
    v_and_b32 v84, 0xffff0000, v70
    v_mul_f32 v82, v20, v82
    v_cvt_pk_bf16_f32 v82, v82, v82
    v_and_b32 v82, 0xffff0000, v82
    v_add_f32 v82, v82, v83
    v_cvt_pk_bf16_f32 v82, v82, v82
    v_and_b32 v82, 0xffff0000, v82
    v_mul_f32 v83, v82, v82
    v_mul_f32 v83, s45, v83
    v_fma_f32 v83, v83, v82, v82
    v_mul_f32 v83, s46, v83
    v_exp_f32 v83, v83
    s_nop 0
    v_add_f32 v83, 1.0, v83
    v_rcp_f32 v83, v83
    s_nop 0
    v_mul_f32 v82, v82, v83
    v_cvt_pk_bf16_f32 v82, v82, v82
    v_and_b32 v82, 0xffff0000, v82
    v_fmac_f32 v21, v82, v84
    v_lshlrev_b32 v82, 16, v39
    v_lshlrev_b32 v83, 16, v55
    v_lshlrev_b32 v84, 16, v71
    v_mul_f32 v82, v20, v82
    v_cvt_pk_bf16_f32 v82, v82, v82
    v_and_b32 v82, 0xffff0000, v82
    v_add_f32 v82, v82, v83
    v_cvt_pk_bf16_f32 v82, v82, v82
    v_and_b32 v82, 0xffff0000, v82
    v_mul_f32 v83, v82, v82
    v_mul_f32 v83, s45, v83
    v_fma_f32 v83, v83, v82, v82
    v_mul_f32 v83, s46, v83
    v_exp_f32 v83, v83
    s_nop 0
    v_add_f32 v83, 1.0, v83
    v_rcp_f32 v83, v83
    s_nop 0
    v_mul_f32 v82, v82, v83
    v_cvt_pk_bf16_f32 v82, v82, v82
    v_and_b32 v82, 0xffff0000, v82
    v_fmac_f32 v21, v82, v84
    v_and_b32 v82, 0xffff0000, v39
    v_and_b32 v83, 0xffff0000, v55
    v_and_b32 v84, 0xffff0000, v71
    v_mul_f32 v82, v20, v82
    v_cvt_pk_bf16_f32 v82, v82, v82
    v_and_b32 v82, 0xffff0000, v82
    v_add_f32 v82, v82, v83
    v_cvt_pk_bf16_f32 v82, v82, v82
    v_and_b32 v82, 0xffff0000, v82
    v_mul_f32 v83, v82, v82
    v_mul_f32 v83, s45, v83
    v_fma_f32 v83, v83, v82, v82
    v_mul_f32 v83, s46, v83
    v_exp_f32 v83, v83
    s_nop 0
    v_add_f32 v83, 1.0, v83
    v_rcp_f32 v83, v83
    s_nop 0
    v_mul_f32 v82, v82, v83
    v_cvt_pk_bf16_f32 v82, v82, v82
    v_and_b32 v82, 0xffff0000, v82
    v_fmac_f32 v21, v82, v84
    v_lshlrev_b32 v82, 16, v40
    v_lshlrev_b32 v83, 16, v56
    v_lshlrev_b32 v84, 16, v72
    v_mul_f32 v82, v20, v82
    v_cvt_pk_bf16_f32 v82, v82, v82
    v_and_b32 v82, 0xffff0000, v82
    v_add_f32 v82, v82, v83
    v_cvt_pk_bf16_f32 v82, v82, v82
    v_and_b32 v82, 0xffff0000, v82
    v_mul_f32 v83, v82, v82
    v_mul_f32 v83, s45, v83
    v_fma_f32 v83, v83, v82, v82
    v_mul_f32 v83, s46, v83
    v_exp_f32 v83, v83
    s_nop 0
    v_add_f32 v83, 1.0, v83
    v_rcp_f32 v83, v83
    s_nop 0
    v_mul_f32 v82, v82, v83
    v_cvt_pk_bf16_f32 v82, v82, v82
    v_and_b32 v82, 0xffff0000, v82
    v_fmac_f32 v21, v82, v84
    v_and_b32 v82, 0xffff0000, v40
    v_and_b32 v83, 0xffff0000, v56
    v_and_b32 v84, 0xffff0000, v72
    v_mul_f32 v82, v20, v82
    v_cvt_pk_bf16_f32 v82, v82, v82
    v_and_b32 v82, 0xffff0000, v82
    v_add_f32 v82, v82, v83
    v_cvt_pk_bf16_f32 v82, v82, v82
    v_and_b32 v82, 0xffff0000, v82
    v_mul_f32 v83, v82, v82
    v_mul_f32 v83, s45, v83
    v_fma_f32 v83, v83, v82, v82
    v_mul_f32 v83, s46, v83
    v_exp_f32 v83, v83
    s_nop 0
    v_add_f32 v83, 1.0, v83
    v_rcp_f32 v83, v83
    s_nop 0
    v_mul_f32 v82, v82, v83
    v_cvt_pk_bf16_f32 v82, v82, v82
    v_and_b32 v82, 0xffff0000, v82
    v_fmac_f32 v21, v82, v84
    v_lshlrev_b32 v82, 16, v41
    v_lshlrev_b32 v83, 16, v57
    v_lshlrev_b32 v84, 16, v73
    v_mul_f32 v82, v20, v82
    v_cvt_pk_bf16_f32 v82, v82, v82
    v_and_b32 v82, 0xffff0000, v82
    v_add_f32 v82, v82, v83
    v_cvt_pk_bf16_f32 v82, v82, v82
    v_and_b32 v82, 0xffff0000, v82
    v_mul_f32 v83, v82, v82
    v_mul_f32 v83, s45, v83
    v_fma_f32 v83, v83, v82, v82
    v_mul_f32 v83, s46, v83
    v_exp_f32 v83, v83
    s_nop 0
    v_add_f32 v83, 1.0, v83
    v_rcp_f32 v83, v83
    s_nop 0
    v_mul_f32 v82, v82, v83
    v_cvt_pk_bf16_f32 v82, v82, v82
    v_and_b32 v82, 0xffff0000, v82
    v_fmac_f32 v21, v82, v84
    v_and_b32 v82, 0xffff0000, v41
    v_and_b32 v83, 0xffff0000, v57
    v_and_b32 v84, 0xffff0000, v73
    v_mul_f32 v82, v20, v82
    v_cvt_pk_bf16_f32 v82, v82, v82
    v_and_b32 v82, 0xffff0000, v82
    v_add_f32 v82, v82, v83
    v_cvt_pk_bf16_f32 v82, v82, v82
    v_and_b32 v82, 0xffff0000, v82
    v_mul_f32 v83, v82, v82
    v_mul_f32 v83, s45, v83
    v_fma_f32 v83, v83, v82, v82
    v_mul_f32 v83, s46, v83
    v_exp_f32 v83, v83
    s_nop 0
    v_add_f32 v83, 1.0, v83
    v_rcp_f32 v83, v83
    s_nop 0
    v_mul_f32 v82, v82, v83
    v_cvt_pk_bf16_f32 v82, v82, v82
    v_and_b32 v82, 0xffff0000, v82
    v_fmac_f32 v21, v82, v84
    v_lshlrev_b32 v82, 16, v42
    v_lshlrev_b32 v83, 16, v58
    v_lshlrev_b32 v84, 16, v74
    v_mul_f32 v82, v20, v82
    v_cvt_pk_bf16_f32 v82, v82, v82
    v_and_b32 v82, 0xffff0000, v82
    v_add_f32 v82, v82, v83
    v_cvt_pk_bf16_f32 v82, v82, v82
    v_and_b32 v82, 0xffff0000, v82
    v_mul_f32 v83, v82, v82
    v_mul_f32 v83, s45, v83
    v_fma_f32 v83, v83, v82, v82
    v_mul_f32 v83, s46, v83
    v_exp_f32 v83, v83
    s_nop 0
    v_add_f32 v83, 1.0, v83
    v_rcp_f32 v83, v83
    s_nop 0
    v_mul_f32 v82, v82, v83
    v_cvt_pk_bf16_f32 v82, v82, v82
    v_and_b32 v82, 0xffff0000, v82
    v_fmac_f32 v21, v82, v84
    v_and_b32 v82, 0xffff0000, v42
    v_and_b32 v83, 0xffff0000, v58
    v_and_b32 v84, 0xffff0000, v74
    v_mul_f32 v82, v20, v82
    v_cvt_pk_bf16_f32 v82, v82, v82
    v_and_b32 v82, 0xffff0000, v82
    v_add_f32 v82, v82, v83
    v_cvt_pk_bf16_f32 v82, v82, v82
    v_and_b32 v82, 0xffff0000, v82
    v_mul_f32 v83, v82, v82
    v_mul_f32 v83, s45, v83
    v_fma_f32 v83, v83, v82, v82
    v_mul_f32 v83, s46, v83
    v_exp_f32 v83, v83
    s_nop 0
    v_add_f32 v83, 1.0, v83
    v_rcp_f32 v83, v83
    s_nop 0
    v_mul_f32 v82, v82, v83
    v_cvt_pk_bf16_f32 v82, v82, v82
    v_and_b32 v82, 0xffff0000, v82
    v_fmac_f32 v21, v82, v84
    v_lshlrev_b32 v82, 16, v43
    v_lshlrev_b32 v83, 16, v59
    v_lshlrev_b32 v84, 16, v75
    v_mul_f32 v82, v20, v82
    v_cvt_pk_bf16_f32 v82, v82, v82
    v_and_b32 v82, 0xffff0000, v82
    v_add_f32 v82, v82, v83
    v_cvt_pk_bf16_f32 v82, v82, v82
    v_and_b32 v82, 0xffff0000, v82
    v_mul_f32 v83, v82, v82
    v_mul_f32 v83, s45, v83
    v_fma_f32 v83, v83, v82, v82
    v_mul_f32 v83, s46, v83
    v_exp_f32 v83, v83
    s_nop 0
    v_add_f32 v83, 1.0, v83
    v_rcp_f32 v83, v83
    s_nop 0
    v_mul_f32 v82, v82, v83
    v_cvt_pk_bf16_f32 v82, v82, v82
    v_and_b32 v82, 0xffff0000, v82
    v_fmac_f32 v21, v82, v84
    v_and_b32 v82, 0xffff0000, v43
    v_and_b32 v83, 0xffff0000, v59
    v_and_b32 v84, 0xffff0000, v75
    v_mul_f32 v82, v20, v82
    v_cvt_pk_bf16_f32 v82, v82, v82
    v_and_b32 v82, 0xffff0000, v82
    v_add_f32 v82, v82, v83
    v_cvt_pk_bf16_f32 v82, v82, v82
    v_and_b32 v82, 0xffff0000, v82
    v_mul_f32 v83, v82, v82
    v_mul_f32 v83, s45, v83
    v_fma_f32 v83, v83, v82, v82
    v_mul_f32 v83, s46, v83
    v_exp_f32 v83, v83
    s_nop 0
    v_add_f32 v83, 1.0, v83
    v_rcp_f32 v83, v83
    s_nop 0
    v_mul_f32 v82, v82, v83
    v_cvt_pk_bf16_f32 v82, v82, v82
    v_and_b32 v82, 0xffff0000, v82
    v_fmac_f32 v21, v82, v84
    v_lshlrev_b32 v82, 16, v44
    v_lshlrev_b32 v83, 16, v60
    v_lshlrev_b32 v84, 16, v76
    v_mul_f32 v82, v20, v82
    v_cvt_pk_bf16_f32 v82, v82, v82
    v_and_b32 v82, 0xffff0000, v82
    v_add_f32 v82, v82, v83
    v_cvt_pk_bf16_f32 v82, v82, v82
    v_and_b32 v82, 0xffff0000, v82
    v_mul_f32 v83, v82, v82
    v_mul_f32 v83, s45, v83
    v_fma_f32 v83, v83, v82, v82
    v_mul_f32 v83, s46, v83
    v_exp_f32 v83, v83
    s_nop 0
    v_add_f32 v83, 1.0, v83
    v_rcp_f32 v83, v83
    s_nop 0
    v_mul_f32 v82, v82, v83
    v_cvt_pk_bf16_f32 v82, v82, v82
    v_and_b32 v82, 0xffff0000, v82
    v_fmac_f32 v21, v82, v84
    v_and_b32 v82, 0xffff0000, v44
    v_and_b32 v83, 0xffff0000, v60
    v_and_b32 v84, 0xffff0000, v76
    v_mul_f32 v82, v20, v82
    v_cvt_pk_bf16_f32 v82, v82, v82
    v_and_b32 v82, 0xffff0000, v82
    v_add_f32 v82, v82, v83
    v_cvt_pk_bf16_f32 v82, v82, v82
    v_and_b32 v82, 0xffff0000, v82
    v_mul_f32 v83, v82, v82
    v_mul_f32 v83, s45, v83
    v_fma_f32 v83, v83, v82, v82
    v_mul_f32 v83, s46, v83
    v_exp_f32 v83, v83
    s_nop 0
    v_add_f32 v83, 1.0, v83
    v_rcp_f32 v83, v83
    s_nop 0
    v_mul_f32 v82, v82, v83
    v_cvt_pk_bf16_f32 v82, v82, v82
    v_and_b32 v82, 0xffff0000, v82
    v_fmac_f32 v21, v82, v84
    v_lshlrev_b32 v82, 16, v45
    v_lshlrev_b32 v83, 16, v61
    v_lshlrev_b32 v84, 16, v77
    v_mul_f32 v82, v20, v82
    v_cvt_pk_bf16_f32 v82, v82, v82
    v_and_b32 v82, 0xffff0000, v82
    v_add_f32 v82, v82, v83
    v_cvt_pk_bf16_f32 v82, v82, v82
    v_and_b32 v82, 0xffff0000, v82
    v_mul_f32 v83, v82, v82
    v_mul_f32 v83, s45, v83
    v_fma_f32 v83, v83, v82, v82
    v_mul_f32 v83, s46, v83
    v_exp_f32 v83, v83
    s_nop 0
    v_add_f32 v83, 1.0, v83
    v_rcp_f32 v83, v83
    s_nop 0
    v_mul_f32 v82, v82, v83
    v_cvt_pk_bf16_f32 v82, v82, v82
    v_and_b32 v82, 0xffff0000, v82
    v_fmac_f32 v21, v82, v84
    v_and_b32 v82, 0xffff0000, v45
    v_and_b32 v83, 0xffff0000, v61
    v_and_b32 v84, 0xffff0000, v77
    v_mul_f32 v82, v20, v82
    v_cvt_pk_bf16_f32 v82, v82, v82
    v_and_b32 v82, 0xffff0000, v82
    v_add_f32 v82, v82, v83
    v_cvt_pk_bf16_f32 v82, v82, v82
    v_and_b32 v82, 0xffff0000, v82
    v_mul_f32 v83, v82, v82
    v_mul_f32 v83, s45, v83
    v_fma_f32 v83, v83, v82, v82
    v_mul_f32 v83, s46, v83
    v_exp_f32 v83, v83
    s_nop 0
    v_add_f32 v83, 1.0, v83
    v_rcp_f32 v83, v83
    s_nop 0
    v_mul_f32 v82, v82, v83
    v_cvt_pk_bf16_f32 v82, v82, v82
    v_and_b32 v82, 0xffff0000, v82
    v_fmac_f32 v21, v82, v84
    s_nop 1
    v_add_f32_dpp v21, v21, v21 row_ror:8 row_mask:0xf bank_mask:0xf
    s_nop 1
    v_add_f32_dpp v21, v21, v21 row_ror:4 row_mask:0xf bank_mask:0xf
    s_nop 1
    v_add_f32_dpp v21, v21, v21 row_ror:2 row_mask:0xf bank_mask:0xf
    s_nop 1
    v_add_f32_dpp v21, v21, v21 row_ror:1 row_mask:0xf bank_mask:0xf
    s_nop 1
    v_readlane_b32 s40, v21, 0
    v_readlane_b32 s41, v21, 16
    v_readlane_b32 s42, v21, 32
    v_readlane_b32 s43, v21, 48
    s_nop 1
    v_mov_b32 v22, s40
    v_add_f32 v22, s41, v22
    v_add_f32 v22, s42, v22
    v_add_f32 v22, s43, v22
    v_cvt_pk_bf16_f32 v22, v22, v22
    v_and_b32 v22, 0xffff0000, v22
    s_waitcnt lgkmcnt(0)
    s_lshl_b32 s44, s44, 16
    v_add_f32 v22, s44, v22
    v_cvt_pk_bf16_f32 v22, v22, v22
    v_and_b32 v22, 0xffff0000, v22
    v_cmp_eq_u32 vcc, 0, v1
    s_and_saveexec_b64 s[36:37], vcc
    s_lshl_b32 s19, s18, 2
    v_mov_b32 v4, s19
    s_mov_b32 s19, 16384
    buffer_store_dword v22, v4, s[24:27], s19 offen
    s_mov_b64 exec, s[36:37]
K1_END:
    s_endpgm
.globl k2_kernel
.p2align 8
.type k2_kernel,@function
k2_kernel:
    s_cmp_ge_u32 s2, 256
    s_cbranch_scc1 K2_END
    s_load_dwordx2 s[4:5], s[0:1], 8
    s_load_dwordx2 s[6:7], s[0:1], 16
    s_load_dwordx2 s[8:9], s[0:1], 96
    v_and_b32 v1, 63, v0
    v_lshrrev_b32 v2, 6, v0
    s_nop 0
    v_readfirstlane_b32 s3, v2
    s_lshr_b32 s10, s2, 5
    s_and_b32 s11, s2, 31
    s_lshl_b32 s12, s10, 24
    s_lshl_b32 s13, s11, 16
    s_add_u32 s12, s12, s13
    s_add_u32 s12, s12, 14680064
    s_waitcnt lgkmcnt(0)
    s_add_u32 s4, s4, s12
    s_addc_u32 s5, s5, 0
    s_add_u32 s6, s6, s12
    s_addc_u32 s7, s7, 0
    s_mov_b32 s20, s4
    s_and_b32 s21, s5, 0xffff
    s_mov_b32 s22, 65536
    s_mov_b32 s23, 0x00020000
    s_mov_b32 s24, s6
    s_and_b32 s25, s7, 0xffff
    s_mov_b32 s26, 65536
    s_mov_b32 s27, 0x00020000
    s_mov_b32 s28, s8
    s_and_b32 s29, s9, 0xffff
    s_mov_b32 s30, 536870912
    s_mov_b32 s31, 0x00020000
    v_and_b32 v3, 15, v1
    v_lshrrev_b32 v4, 4, v1
    v_lshlrev_b32 v5, 9, v3
    v_lshl_add_u32 v5, v4, 4, v5
    s_lshl_b32 s14, s10, 10
    v_add_u32 v5, s14, v5
    v_cmp_gt_u32 vcc, 2, v3
    v_mov_b32 v6, 0x7ffffff0
    s_nop 1
    v_cndmask_b32 v5, v6, v5, vcc
    buffer_load_dwordx4 v[160:163], v5, s[28:31], 0 offen offset:0
    buffer_load_dwordx4 v[164:167], v5, s[28:31], 0 offen offset:64
    buffer_load_dwordx4 v[168:171], v5, s[28:31], 0 offen offset:128
    buffer_load_dwordx4 v[172:175], v5, s[28:31], 0 offen offset:192
    buffer_load_dwordx4 v[176:179], v5, s[28:31], 0 offen offset:256
    buffer_load_dwordx4 v[180:183], v5, s[28:31], 0 offen offset:320
    buffer_load_dwordx4 v[184:187], v5, s[28:31], 0 offen offset:384
    buffer_load_dwordx4 v[188:191], v5, s[28:31], 0 offen offset:448
    s_lshl_b32 s14, s3, 5
    v_add_u32 v7, s14, v3
    v_lshlrev_b32 v7, 9, v7
    v_lshl_add_u32 v7, v4, 4, v7
    s_mov_b32 s15, 8192
    buffer_load_dwordx4 v[16:19], v7, s[20:23], 0 offen offset:0
    buffer_load_dwordx4 v[20:23], v7, s[20:23], 0 offen offset:64
    buffer_load_dwordx4 v[24:27], v7, s[20:23], 0 offen offset:128
    buffer_load_dwordx4 v[28:31], v7, s[20:23], 0 offen offset:192
    buffer_load_dwordx4 v[32:35], v7, s[20:23], 0 offen offset:256
    buffer_load_dwordx4 v[36:39], v7, s[20:23], 0 offen offset:320
    buffer_load_dwordx4 v[40:43], v7, s[20:23], 0 offen offset:384
    buffer_load_dwordx4 v[44:47], v7, s[20:23], 0 offen offset:448
    buffer_load_dwordx4 v[48:51], v7, s[20:23], s15 offen offset:0
    buffer_load_dwordx4 v[52:55], v7, s[20:23], s15 offen offset:64
    buffer_load_dwordx4 v[56:59], v7, s[20:23], s15 offen offset:128
    buffer_load_dwordx4 v[60:63], v7, s[20:23], s15 offen offset:192
    buffer_load_dwordx4 v[64:67], v7, s[20:23], s15 offen offset:256
    buffer_load_dwordx4 v[68:71], v7, s[20:23], s15 offen offset:320
    buffer_load_dwordx4 v[72:75], v7, s[20:23], s15 offen offset:384
    buffer_load_dwordx4 v[76:79], v7, s[20:23], s15 offen offset:448
    v_lshrrev_b32 v8, 5, v1
    v_add_u32 v9, s14, v8
    v_lshlrev_b32 v9, 9, v9
    v_and_b32 v10, 31, v1
    v_lshl_add_u32 v9, v10, 4, v9
    s_mov_b32 s16, 4096
    s_mov_b32 s17, 12288
    buffer_load_dwordx4 v[80:83], v9, s[24:27], 0 offen offset:0
    buffer_load_dwordx4 v[84:87], v9, s[24:27], 0 offen offset:1024
    buffer_load_dwordx4 v[88:91], v9, s[24:27], 0 offen offset:2048
    buffer_load_dwordx4 v[92:95], v9, s[24:27], 0 offen offset:3072
    buffer_load_dwordx4 v[96:99], v9, s[24:27], s16 offen offset:0
    buffer_load_dwordx4 v[100:103], v9, s[24:27], s16 offen offset:1024
    buffer_load_dwordx4 v[104:107], v9, s[24:27], s16 offen offset:2048
    buffer_load_dwordx4 v[108:111], v9, s[24:27], s16 offen offset:3072
    buffer_load_dwordx4 v[112:115], v9, s[24:27], s15 offen offset:0
    buffer_load_dwordx4 v[116:119], v9, s[24:27], s15 offen offset:1024
    buffer_load_dwordx4 v[120:123], v9, s[24:27], s15 offen offset:2048
    buffer_load_dwordx4 v[124:127], v9, s[24:27], s15 offen offset:3072
    buffer_load_dwordx4 v[128:131], v9, s[24:27], s17 offen offset:0
    buffer_load_dwordx4 v[132:135], v9, s[24:27], s17 offen offset:1024
    buffer_load_dwordx4 v[136:139], v9, s[24:27], s17 offen offset:2048
    buffer_load_dwordx4 v[140:143], v9, s[24:27], s17 offen offset:3072
    s_waitcnt vmcnt(24)
    v_mfma_f32_16x16x32_bf16 v[192:195], v[160:163], v[16:19], 0
    v_mfma_f32_16x16x32_bf16 v[192:195], v[164:167], v[20:23], v[192:195]
    v_mfma_f32_16x16x32_bf16 v[192:195], v[168:171], v[24:27], v[192:195]
    v_mfma_f32_16x16x32_bf16 v[192:195], v[172:175], v[28:31], v[192:195]
    v_mfma_f32_16x16x32_bf16 v[192:195], v[176:179], v[32:35], v[192:195]
    v_mfma_f32_16x16x32_bf16 v[192:195], v[180:183], v[36:39], v[192:195]
    v_mfma_f32_16x16x32_bf16 v[192:195], v[184:187], v[40:43], v[192:195]
    v_mfma_f32_16x16x32_bf16 v[192:195], v[188:191], v[44:47], v[192:195]
    s_waitcnt vmcnt(16)
    v_mfma_f32_16x16x32_bf16 v[196:199], v[160:163], v[48:51], 0
    v_mfma_f32_16x16x32_bf16 v[196:199], v[164:167], v[52:55], v[196:199]
    v_mfma_f32_16x16x32_bf16 v[196:199], v[168:171], v[56:59], v[196:199]
    v_mfma_f32_16x16x32_bf16 v[196:199], v[172:175], v[60:63], v[196:199]
    v_mfma_f32_16x16x32_bf16 v[196:199], v[176:179], v[64:67], v[196:199]
    v_mfma_f32_16x16x32_bf16 v[196:199], v[180:183], v[68:71], v[196:199]
    v_mfma_f32_16x16x32_bf16 v[196:199], v[184:187], v[72:75], v[196:199]
    v_mfma_f32_16x16x32_bf16 v[196:199], v[188:191], v[76:79], v[196:199]
    s_nop 7
    s_nop 3
    v_cvt_pk_bf16_f32 v204, v192, v193
    v_cvt_pk_bf16_f32 v205, v196, v197
    v_lshlrev_b32 v200, 16, v204
    v_and_b32 v201, 0xffff0000, v204
    v_lshlrev_b32 v202, 16, v205
    v_and_b32 v203, 0xffff0000, v205
    v_mul_f32 v200, 0x3d800000, v200
    v_mul_f32 v201, 0x3d800000, v201
    v_mul_f32 v202, 0x3d800000, v202
    v_mul_f32 v203, 0x3d800000, v203
    v_max_f32 v204, v200, v202
    v_max_f32 v205, v201, v203
    s_nop 1
    v_max_f32_dpp v204, v204, v204 row_ror:8 row_mask:0xf bank_mask:0xf
    s_nop 1
    v_max_f32_dpp v204, v204, v204 row_ror:4 row_mask:0xf bank_mask:0xf
    s_nop 1
    v_max_f32_dpp v204, v204, v204 row_ror:2 row_mask:0xf bank_mask:0xf
    s_nop 1
    v_max_f32_dpp v204, v204, v204 row_ror:1 row_mask:0xf bank_mask:0xf
    s_nop 1
    v_max_f32_dpp v205, v205, v205 row_ror:8 row_mask:0xf bank_mask:0xf
    s_nop 1
    v_max_f32_dpp v205, v205, v205 row_ror:4 row_mask:0xf bank_mask:0xf
    s_nop 1
    v_max_f32_dpp v205, v205, v205 row_ror:2 row_mask:0xf bank_mask:0xf
    s_nop 1
    v_max_f32_dpp v205, v205, v205 row_ror:1 row_mask:0xf bank_mask:0xf
    s_lshl_b32 s18, s3, 3
    v_mov_b32 v206, s18
    v_cmp_eq_u32 vcc, 0, v1
    s_and_saveexec_b64 s[36:37], vcc
    ds_write_b64 v206, v[204:205]
    s_mov_b64 exec, s[36:37]
    s_waitcnt lgkmcnt(0)
    s_barrier
    v_mov_b32 v207, 0
    ds_read_b128 v[208:211], v207
    ds_read_b128 v[212:215], v207 offset:16
    s_waitcnt lgkmcnt(0)
    v_max_f32 v208, v208, v210
    v_max_f32 v209, v209, v211
    v_max_f32 v212, v212, v214
    v_max_f32 v213, v213, v215
    v_max_f32 v208, v208, v212
    v_max_f32 v209, v209, v213
    s_mov_b32 s19, 0x3fb8aa3b
    v_sub_f32 v200, v200, v208
    v_mul_f32 v200, s19, v200
    v_sub_f32 v201, v201, v209
    v_mul_f32 v201, s19, v201
    v_sub_f32 v202, v202, v208
    v_mul_f32 v202, s19, v202
    v_sub_f32 v203, v203, v209
    v_mul_f32 v203, s19, v203
    v_exp_f32 v200, v200
    v_exp_f32 v201, v201
    v_exp_f32 v202, v202
    v_exp_f32 v203, v203
    s_nop 0
    v_add_f32 v204, v200, v202
    v_add_f32 v205, v201, v203
    s_nop 1
    v_add_f32_dpp v204, v204, v204 row_ror:8 row_mask:0xf bank_mask:0xf
    s_nop 1
    v_add_f32_dpp v204, v204, v204 row_ror:4 row_mask:0xf bank_mask:0xf
    s_nop 1
    v_add_f32_dpp v204, v204, v204 row_ror:2 row_mask:0xf bank_mask:0xf
    s_nop 1
    v_add_f32_dpp v204, v204, v204 row_ror:1 row_mask:0xf bank_mask:0xf
    s_nop 1
    v_add_f32_dpp v205, v205, v205 row_ror:8 row_mask:0xf bank_mask:0xf
    s_nop 1
    v_add_f32_dpp v205, v205, v205 row_ror:4 row_mask:0xf bank_mask:0xf
    s_nop 1
    v_add_f32_dpp v205, v205, v205 row_ror:2 row_mask:0xf bank_mask:0xf
    s_nop 1
    v_add_f32_dpp v205, v205, v205 row_ror:1 row_mask:0xf bank_mask:0xf
    s_lshl_b32 s18, s3, 8
    v_lshlrev_b32 v207, 3, v1
    v_add_u32 v207, s18, v207
    v_cmp_gt_u32 vcc, 16, v1
    s_and_saveexec_b64 s[36:37], vcc
    ds_write_b64 v207, v[200:201] offset:256
    ds_write_b64 v207, v[202:203] offset:384
    s_mov_b64 exec, s[36:37]
    v_cmp_eq_u32 vcc, 0, v1
    s_and_saveexec_b64 s[36:37], vcc
    ds_write_b64 v206, v[204:205] offset:32
    s_mov_b64 exec, s[36:37]
    s_waitcnt lgkmcnt(0)
    v_lshlrev_b32 v207, 3, v8
    v_add_u32 v207, s18, v207
    ds_read_b64 v[216:217], v207 offset:256
    ds_read_b64 v[218:219], v207 offset:272
    ds_read_b64 v[220:221], v207 offset:288
    ds_read_b64 v[222:223], v207 offset:304
    ds_read_b64 v[224:225], v207 offset:320
    ds_read_b64 v[226:227], v207 offset:336
    ds_read_b64 v[228:229], v207 offset:352
    ds_read_b64 v[230:231], v207 offset:368
    ds_read_b64 v[232:233], v207 offset:384
    ds_read_b64 v[234:235], v207 offset:400
    ds_read_b64 v[236:237], v207 offset:416
    ds_read_b64 v[238:239], v207 offset:432
    ds_read_b64 v[240:241], v207 offset:448
    ds_read_b64 v[242:243], v207 offset:464
    ds_read_b64 v[244:245], v207 offset:480
    ds_read_b64 v[246:247], v207 offset:496
    v_mov_b32 v144, 0
    v_mov_b32 v145, 0
    v_mov_b32 v146, 0
    v_mov_b32 v147, 0
    v_mov_b32 v148, 0
    v_mov_b32 v149, 0
    v_mov_b32 v150, 0
    v_mov_b32 v151, 0
    v_mov_b32 v152, 0
    v_mov_b32 v153, 0
    v_mov_b32 v154, 0
    v_mov_b32 v155, 0
    v_mov_b32 v156, 0
    v_mov_b32 v157, 0
    v_mov_b32 v158, 0
    v_mov_b32 v159, 0
    s_waitcnt vmcnt(15) lgkmcnt(15)
    v_lshlrev_b32 v10, 16, v80
    v_and_b32 v11, 0xffff0000, v80
    v_fmac_f32 v144, v216, v10
    v_fmac_f32 v145, v216, v11
    v_fmac_f32 v152, v217, v10
    v_fmac_f32 v153, v217, v11
    v_lshlrev_b32 v10, 16, v81
    v_and_b32 v11, 0xffff0000, v81
    v_fmac_f32 v146, v216, v10
    v_fmac_f32 v147, v216, v11
    v_fmac_f32 v154, v217, v10
    v_fmac_f32 v155, v217, v11
    v_lshlrev_b32 v10, 16, v82
    v_and_b32 v11, 0xffff0000, v82
    v_fmac_f32 v148, v216, v10
    v_fmac_f32 v149, v216, v11
    v_fmac_f32 v156, v217, v10
    v_fmac_f32 v157, v217, v11
    v_lshlrev_b32 v10, 16, v83
    v_and_b32 v11, 0xffff0000, v83
    v_fmac_f32 v150, v216, v10
    v_fmac_f32 v151, v216, v11
    v_fmac_f32 v158, v217, v10
    v_fmac_f32 v159, v217, v11
    s_waitcnt vmcnt(14) lgkmcnt(14)
    v_lshlrev_b32 v10, 16, v84
    v_and_b32 v11, 0xffff0000, v84
    v_fmac_f32 v144, v218, v10
    v_fmac_f32 v145, v218, v11
    v_fmac_f32 v152, v219, v10
    v_fmac_f32 v153, v219, v11
    v_lshlrev_b32 v10, 16, v85
    v_and_b32 v11, 0xffff0000, v85
    v_fmac_f32 v146, v218, v10
    v_fmac_f32 v147, v218, v11
    v_fmac_f32 v154, v219, v10
    v_fmac_f32 v155, v219, v11
    v_lshlrev_b32 v10, 16, v86
    v_and_b32 v11, 0xffff0000, v86
    v_fmac_f32 v148, v218, v10
    v_fmac_f32 v149, v218, v11
    v_fmac_f32 v156, v219, v10
    v_fmac_f32 v157, v219, v11
    v_lshlrev_b32 v10, 16, v87
    v_and_b32 v11, 0xffff0000, v87
    v_fmac_f32 v150, v218, v10
    v_fmac_f32 v151, v218, v11
    v_fmac_f32 v158, v219, v10
    v_fmac_f32 v159, v219, v11
    s_waitcnt vmcnt(13) lgkmcnt(13)
    v_lshlrev_b32 v10, 16, v88
    v_and_b32 v11, 0xffff0000, v88
    v_fmac_f32 v144, v220, v10
    v_fmac_f32 v145, v220, v11
    v_fmac_f32 v152, v221, v10
    v_fmac_f32 v153, v221, v11
    v_lshlrev_b32 v10, 16, v89
    v_and_b32 v11, 0xffff0000, v89
    v_fmac_f32 v146, v220, v10
    v_fmac_f32 v147, v220, v11
    v_fmac_f32 v154, v221, v10
    v_fmac_f32 v155, v221, v11
    v_lshlrev_b32 v10, 16, v90
    v_and_b32 v11, 0xffff0000, v90
    v_fmac_f32 v148, v220, v10
    v_fmac_f32 v149, v220, v11
    v_fmac_f32 v156, v221, v10
    v_fmac_f32 v157, v221, v11
    v_lshlrev_b32 v10, 16, v91
    v_and_b32 v11, 0xffff0000, v91
    v_fmac_f32 v150, v220, v10
    v_fmac_f32 v151, v220, v11
    v_fmac_f32 v158, v221, v10
    v_fmac_f32 v159, v221, v11
    s_waitcnt vmcnt(12) lgkmcnt(12)
    v_lshlrev_b32 v10, 16, v92
    v_and_b32 v11, 0xffff0000, v92
    v_fmac_f32 v144, v222, v10
    v_fmac_f32 v145, v222, v11
    v_fmac_f32 v152, v223, v10
    v_fmac_f32 v153, v223, v11
    v_lshlrev_b32 v10, 16, v93
    v_and_b32 v11, 0xffff0000, v93
    v_fmac_f32 v146, v222, v10
    v_fmac_f32 v147, v222, v11
    v_fmac_f32 v154, v223, v10
    v_fmac_f32 v155, v223, v11
    v_lshlrev_b32 v10, 16, v94
    v_and_b32 v11, 0xffff0000, v94
    v_fmac_f32 v148, v222, v10
    v_fmac_f32 v149, v222, v11
    v_fmac_f32 v156, v223, v10
    v_fmac_f32 v157, v223, v11
    v_lshlrev_b32 v10, 16, v95
    v_and_b32 v11, 0xffff0000, v95
    v_fmac_f32 v150, v222, v10
    v_fmac_f32 v151, v222, v11
    v_fmac_f32 v158, v223, v10
    v_fmac_f32 v159, v223, v11
    s_waitcnt vmcnt(11) lgkmcnt(11)
    v_lshlrev_b32 v10, 16, v96
    v_and_b32 v11, 0xffff0000, v96
    v_fmac_f32 v144, v224, v10
    v_fmac_f32 v145, v224, v11
    v_fmac_f32 v152, v225, v10
    v_fmac_f32 v153, v225, v11
    v_lshlrev_b32 v10, 16, v97
    v_and_b32 v11, 0xffff0000, v97
    v_fmac_f32 v146, v224, v10
    v_fmac_f32 v147, v224, v11
    v_fmac_f32 v154, v225, v10
    v_fmac_f32 v155, v225, v11
    v_lshlrev_b32 v10, 16, v98
    v_and_b32 v11, 0xffff0000, v98
    v_fmac_f32 v148, v224, v10
    v_fmac_f32 v149, v224, v11
    v_fmac_f32 v156, v225, v10
    v_fmac_f32 v157, v225, v11
    v_lshlrev_b32 v10, 16, v99
    v_and_b32 v11, 0xffff0000, v99
    v_fmac_f32 v150, v224, v10
    v_fmac_f32 v151, v224, v11
    v_fmac_f32 v158, v225, v10
    v_fmac_f32 v159, v225, v11
    s_waitcnt vmcnt(10) lgkmcnt(10)
    v_lshlrev_b32 v10, 16, v100
    v_and_b32 v11, 0xffff0000, v100
    v_fmac_f32 v144, v226, v10
    v_fmac_f32 v145, v226, v11
    v_fmac_f32 v152, v227, v10
    v_fmac_f32 v153, v227, v11
    v_lshlrev_b32 v10, 16, v101
    v_and_b32 v11, 0xffff0000, v101
    v_fmac_f32 v146, v226, v10
    v_fmac_f32 v147, v226, v11
    v_fmac_f32 v154, v227, v10
    v_fmac_f32 v155, v227, v11
    v_lshlrev_b32 v10, 16, v102
    v_and_b32 v11, 0xffff0000, v102
    v_fmac_f32 v148, v226, v10
    v_fmac_f32 v149, v226, v11
    v_fmac_f32 v156, v227, v10
    v_fmac_f32 v157, v227, v11
    v_lshlrev_b32 v10, 16, v103
    v_and_b32 v11, 0xffff0000, v103
    v_fmac_f32 v150, v226, v10
    v_fmac_f32 v151, v226, v11
    v_fmac_f32 v158, v227, v10
    v_fmac_f32 v159, v227, v11
    s_waitcnt vmcnt(9) lgkmcnt(9)
    v_lshlrev_b32 v10, 16, v104
    v_and_b32 v11, 0xffff0000, v104
    v_fmac_f32 v144, v228, v10
    v_fmac_f32 v145, v228, v11
    v_fmac_f32 v152, v229, v10
    v_fmac_f32 v153, v229, v11
    v_lshlrev_b32 v10, 16, v105
    v_and_b32 v11, 0xffff0000, v105
    v_fmac_f32 v146, v228, v10
    v_fmac_f32 v147, v228, v11
    v_fmac_f32 v154, v229, v10
    v_fmac_f32 v155, v229, v11
    v_lshlrev_b32 v10, 16, v106
    v_and_b32 v11, 0xffff0000, v106
    v_fmac_f32 v148, v228, v10
    v_fmac_f32 v149, v228, v11
    v_fmac_f32 v156, v229, v10
    v_fmac_f32 v157, v229, v11
    v_lshlrev_b32 v10, 16, v107
    v_and_b32 v11, 0xffff0000, v107
    v_fmac_f32 v150, v228, v10
    v_fmac_f32 v151, v228, v11
    v_fmac_f32 v158, v229, v10
    v_fmac_f32 v159, v229, v11
    s_waitcnt vmcnt(8) lgkmcnt(8)
    v_lshlrev_b32 v10, 16, v108
    v_and_b32 v11, 0xffff0000, v108
    v_fmac_f32 v144, v230, v10
    v_fmac_f32 v145, v230, v11
    v_fmac_f32 v152, v231, v10
    v_fmac_f32 v153, v231, v11
    v_lshlrev_b32 v10, 16, v109
    v_and_b32 v11, 0xffff0000, v109
    v_fmac_f32 v146, v230, v10
    v_fmac_f32 v147, v230, v11
    v_fmac_f32 v154, v231, v10
    v_fmac_f32 v155, v231, v11
    v_lshlrev_b32 v10, 16, v110
    v_and_b32 v11, 0xffff0000, v110
    v_fmac_f32 v148, v230, v10
    v_fmac_f32 v149, v230, v11
    v_fmac_f32 v156, v231, v10
    v_fmac_f32 v157, v231, v11
    v_lshlrev_b32 v10, 16, v111
    v_and_b32 v11, 0xffff0000, v111
    v_fmac_f32 v150, v230, v10
    v_fmac_f32 v151, v230, v11
    v_fmac_f32 v158, v231, v10
    v_fmac_f32 v159, v231, v11
    s_waitcnt vmcnt(7) lgkmcnt(7)
    v_lshlrev_b32 v10, 16, v112
    v_and_b32 v11, 0xffff0000, v112
    v_fmac_f32 v144, v232, v10
    v_fmac_f32 v145, v232, v11
    v_fmac_f32 v152, v233, v10
    v_fmac_f32 v153, v233, v11
    v_lshlrev_b32 v10, 16, v113
    v_and_b32 v11, 0xffff0000, v113
    v_fmac_f32 v146, v232, v10
    v_fmac_f32 v147, v232, v11
    v_fmac_f32 v154, v233, v10
    v_fmac_f32 v155, v233, v11
    v_lshlrev_b32 v10, 16, v114
    v_and_b32 v11, 0xffff0000, v114
    v_fmac_f32 v148, v232, v10
    v_fmac_f32 v149, v232, v11
    v_fmac_f32 v156, v233, v10
    v_fmac_f32 v157, v233, v11
    v_lshlrev_b32 v10, 16, v115
    v_and_b32 v11, 0xffff0000, v115
    v_fmac_f32 v150, v232, v10
    v_fmac_f32 v151, v232, v11
    v_fmac_f32 v158, v233, v10
    v_fmac_f32 v159, v233, v11
    s_waitcnt vmcnt(6) lgkmcnt(6)
    v_lshlrev_b32 v10, 16, v116
    v_and_b32 v11, 0xffff0000, v116
    v_fmac_f32 v144, v234, v10
    v_fmac_f32 v145, v234, v11
    v_fmac_f32 v152, v235, v10
    v_fmac_f32 v153, v235, v11
    v_lshlrev_b32 v10, 16, v117
    v_and_b32 v11, 0xffff0000, v117
    v_fmac_f32 v146, v234, v10
    v_fmac_f32 v147, v234, v11
    v_fmac_f32 v154, v235, v10
    v_fmac_f32 v155, v235, v11
    v_lshlrev_b32 v10, 16, v118
    v_and_b32 v11, 0xffff0000, v118
    v_fmac_f32 v148, v234, v10
    v_fmac_f32 v149, v234, v11
    v_fmac_f32 v156, v235, v10
    v_fmac_f32 v157, v235, v11
    v_lshlrev_b32 v10, 16, v119
    v_and_b32 v11, 0xffff0000, v119
    v_fmac_f32 v150, v234, v10
    v_fmac_f32 v151, v234, v11
    v_fmac_f32 v158, v235, v10
    v_fmac_f32 v159, v235, v11
    s_waitcnt vmcnt(5) lgkmcnt(5)
    v_lshlrev_b32 v10, 16, v120
    v_and_b32 v11, 0xffff0000, v120
    v_fmac_f32 v144, v236, v10
    v_fmac_f32 v145, v236, v11
    v_fmac_f32 v152, v237, v10
    v_fmac_f32 v153, v237, v11
    v_lshlrev_b32 v10, 16, v121
    v_and_b32 v11, 0xffff0000, v121
    v_fmac_f32 v146, v236, v10
    v_fmac_f32 v147, v236, v11
    v_fmac_f32 v154, v237, v10
    v_fmac_f32 v155, v237, v11
    v_lshlrev_b32 v10, 16, v122
    v_and_b32 v11, 0xffff0000, v122
    v_fmac_f32 v148, v236, v10
    v_fmac_f32 v149, v236, v11
    v_fmac_f32 v156, v237, v10
    v_fmac_f32 v157, v237, v11
    v_lshlrev_b32 v10, 16, v123
    v_and_b32 v11, 0xffff0000, v123
    v_fmac_f32 v150, v236, v10
    v_fmac_f32 v151, v236, v11
    v_fmac_f32 v158, v237, v10
    v_fmac_f32 v159, v237, v11
    s_waitcnt vmcnt(4) lgkmcnt(4)
    v_lshlrev_b32 v10, 16, v124
    v_and_b32 v11, 0xffff0000, v124
    v_fmac_f32 v144, v238, v10
    v_fmac_f32 v145, v238, v11
    v_fmac_f32 v152, v239, v10
    v_fmac_f32 v153, v239, v11
    v_lshlrev_b32 v10, 16, v125
    v_and_b32 v11, 0xffff0000, v125
    v_fmac_f32 v146, v238, v10
    v_fmac_f32 v147, v238, v11
    v_fmac_f32 v154, v239, v10
    v_fmac_f32 v155, v239, v11
    v_lshlrev_b32 v10, 16, v126
    v_and_b32 v11, 0xffff0000, v126
    v_fmac_f32 v148, v238, v10
    v_fmac_f32 v149, v238, v11
    v_fmac_f32 v156, v239, v10
    v_fmac_f32 v157, v239, v11
    v_lshlrev_b32 v10, 16, v127
    v_and_b32 v11, 0xffff0000, v127
    v_fmac_f32 v150, v238, v10
    v_fmac_f32 v151, v238, v11
    v_fmac_f32 v158, v239, v10
    v_fmac_f32 v159, v239, v11
    s_waitcnt vmcnt(3) lgkmcnt(3)
    v_lshlrev_b32 v10, 16, v128
    v_and_b32 v11, 0xffff0000, v128
    v_fmac_f32 v144, v240, v10
    v_fmac_f32 v145, v240, v11
    v_fmac_f32 v152, v241, v10
    v_fmac_f32 v153, v241, v11
    v_lshlrev_b32 v10, 16, v129
    v_and_b32 v11, 0xffff0000, v129
    v_fmac_f32 v146, v240, v10
    v_fmac_f32 v147, v240, v11
    v_fmac_f32 v154, v241, v10
    v_fmac_f32 v155, v241, v11
    v_lshlrev_b32 v10, 16, v130
    v_and_b32 v11, 0xffff0000, v130
    v_fmac_f32 v148, v240, v10
    v_fmac_f32 v149, v240, v11
    v_fmac_f32 v156, v241, v10
    v_fmac_f32 v157, v241, v11
    v_lshlrev_b32 v10, 16, v131
    v_and_b32 v11, 0xffff0000, v131
    v_fmac_f32 v150, v240, v10
    v_fmac_f32 v151, v240, v11
    v_fmac_f32 v158, v241, v10
    v_fmac_f32 v159, v241, v11
    s_waitcnt vmcnt(2) lgkmcnt(2)
    v_lshlrev_b32 v10, 16, v132
    v_and_b32 v11, 0xffff0000, v132
    v_fmac_f32 v144, v242, v10
    v_fmac_f32 v145, v242, v11
    v_fmac_f32 v152, v243, v10
    v_fmac_f32 v153, v243, v11
    v_lshlrev_b32 v10, 16, v133
    v_and_b32 v11, 0xffff0000, v133
    v_fmac_f32 v146, v242, v10
    v_fmac_f32 v147, v242, v11
    v_fmac_f32 v154, v243, v10
    v_fmac_f32 v155, v243, v11
    v_lshlrev_b32 v10, 16, v134
    v_and_b32 v11, 0xffff0000, v134
    v_fmac_f32 v148, v242, v10
    v_fmac_f32 v149, v242, v11
    v_fmac_f32 v156, v243, v10
    v_fmac_f32 v157, v243, v11
    v_lshlrev_b32 v10, 16, v135
    v_and_b32 v11, 0xffff0000, v135
    v_fmac_f32 v150, v242, v10
    v_fmac_f32 v151, v242, v11
    v_fmac_f32 v158, v243, v10
    v_fmac_f32 v159, v243, v11
    s_waitcnt vmcnt(1) lgkmcnt(1)
    v_lshlrev_b32 v10, 16, v136
    v_and_b32 v11, 0xffff0000, v136
    v_fmac_f32 v144, v244, v10
    v_fmac_f32 v145, v244, v11
    v_fmac_f32 v152, v245, v10
    v_fmac_f32 v153, v245, v11
    v_lshlrev_b32 v10, 16, v137
    v_and_b32 v11, 0xffff0000, v137
    v_fmac_f32 v146, v244, v10
    v_fmac_f32 v147, v244, v11
    v_fmac_f32 v154, v245, v10
    v_fmac_f32 v155, v245, v11
    v_lshlrev_b32 v10, 16, v138
    v_and_b32 v11, 0xffff0000, v138
    v_fmac_f32 v148, v244, v10
    v_fmac_f32 v149, v244, v11
    v_fmac_f32 v156, v245, v10
    v_fmac_f32 v157, v245, v11
    v_lshlrev_b32 v10, 16, v139
    v_and_b32 v11, 0xffff0000, v139
    v_fmac_f32 v150, v244, v10
    v_fmac_f32 v151, v244, v11
    v_fmac_f32 v158, v245, v10
    v_fmac_f32 v159, v245, v11
    s_waitcnt vmcnt(0) lgkmcnt(0)
    v_lshlrev_b32 v10, 16, v140
    v_and_b32 v11, 0xffff0000, v140
    v_fmac_f32 v144, v246, v10
    v_fmac_f32 v145, v246, v11
    v_fmac_f32 v152, v247, v10
    v_fmac_f32 v153, v247, v11
    v_lshlrev_b32 v10, 16, v141
    v_and_b32 v11, 0xffff0000, v141
    v_fmac_f32 v146, v246, v10
    v_fmac_f32 v147, v246, v11
    v_fmac_f32 v154, v247, v10
    v_fmac_f32 v155, v247, v11
    v_lshlrev_b32 v10, 16, v142
    v_and_b32 v11, 0xffff0000, v142
    v_fmac_f32 v148, v246, v10
    v_fmac_f32 v149, v246, v11
    v_fmac_f32 v156, v247, v10
    v_fmac_f32 v157, v247, v11
    v_lshlrev_b32 v10, 16, v143
    v_and_b32 v11, 0xffff0000, v143
    v_fmac_f32 v150, v246, v10
    v_fmac_f32 v151, v246, v11
    v_fmac_f32 v158, v247, v10
    v_fmac_f32 v159, v247, v11
    s_lshl_b32 s18, s3, 1
    v_add_u32 v10, s18, v8
    v_lshlrev_b32 v10, 11, v10
    v_and_b32 v11, 31, v1
    v_lshl_add_u32 v10, v11, 5, v10
    ds_write_b128 v10, v[144:147] offset:4096
    ds_write_b128 v10, v[148:151] offset:4112
    ds_write_b128 v10, v[152:155] offset:5120
    ds_write_b128 v10, v[156:159] offset:5136
    s_waitcnt lgkmcnt(0)
    s_barrier
    v_lshlrev_b32 v10, 3, v0
    ds_read_b64 v[16:17], v10 offset:4096
    ds_read_b64 v[18:19], v10 offset:6144
    ds_read_b64 v[20:21], v10 offset:8192
    ds_read_b64 v[22:23], v10 offset:10240
    ds_read_b64 v[24:25], v10 offset:12288
    ds_read_b64 v[26:27], v10 offset:14336
    ds_read_b64 v[28:29], v10 offset:16384
    ds_read_b64 v[30:31], v10 offset:18432
    v_mov_b32 v207, 0
    ds_read_b128 v[40:43], v207 offset:32
    ds_read_b128 v[44:47], v207 offset:48
    s_waitcnt lgkmcnt(0)
    v_add_f32 v16, v16, v18
    v_add_f32 v17, v17, v19
    v_add_f32 v16, v16, v20
    v_add_f32 v17, v17, v21
    v_add_f32 v16, v16, v22
    v_add_f32 v17, v17, v23
    v_add_f32 v16, v16, v24
    v_add_f32 v17, v17, v25
    v_add_f32 v16, v16, v26
    v_add_f32 v17, v17, v27
    v_add_f32 v16, v16, v28
    v_add_f32 v17, v17, v29
    v_add_f32 v16, v16, v30
    v_add_f32 v17, v17, v31
    s_lshl_b32 s18, s2, 11
    v_add_u32 v10, s18, v10
    s_mov_b32 s19, 65536
    buffer_store_dwordx2 v[16:17], v10, s[28:31], s19 offen
    v_add_f32 v40, v40, v42
    v_add_f32 v41, v41, v43
    v_add_f32 v44, v44, v46
    v_add_f32 v45, v45, v47
    v_add_f32 v49, v40, v44
    v_add_f32 v51, v41, v45
    v_mov_b32 v48, v208
    v_mov_b32 v50, v209
    v_cmp_eq_u32 vcc, 0, v0
    s_and_saveexec_b64 s[36:37], vcc
    s_lshl_b32 s18, s2, 4
    v_mov_b32 v10, s18
    s_mov_b32 s19, 589824
    buffer_store_dwordx4 v[48:51], v10, s[28:31], s19 offen
    s_mov_b64 exec, s[36:37]
K2_END:
    s_endpgm
.globl k3_kernel
.p2align 8
.type k3_kernel,@function
k3_kernel:
    s_cmp_ge_u32 s2, 128
    s_cbranch_scc1 K3_END
    s_load_dwordx2 s[4:5], s[0:1], 32
    s_load_dwordx2 s[8:9], s[0:1], 96
    v_and_b32 v1, 63, v0
    v_lshrrev_b32 v2, 6, v0
    s_nop 0
    v_readfirstlane_b32 s3, v2
    s_lshr_b32 s10, s2, 3
    s_and_b32 s11, s2, 7
    s_lshr_b32 s12, s10, 1
    s_and_b32 s13, s10, 1
    s_waitcnt lgkmcnt(0)
    s_mov_b32 s20, s4
    s_and_b32 s21, s5, 0xffff
    s_mov_b32 s22, 3670016
    s_mov_b32 s23, 0x00020000
    s_mov_b32 s28, s8
    s_and_b32 s29, s9, 0xffff
    s_mov_b32 s30, 536870912
    s_mov_b32 s31, 0x00020000
    s_lshl_b32 s14, s2, 5
    s_lshl_b32 s15, s3, 3
    s_add_u32 s14, s14, s15
    s_mul_i32 s14, s14, 896
    v_lshlrev_b32 v3, 4, v1
    v_add_u32 v3, s14, v3
    v_cmp_gt_u32 vcc, 56, v1
    v_mov_b32 v6, 0x7ffffff0
    s_nop 1
    v_cndmask_b32 v3, v6, v3, vcc
    buffer_load_dwordx4 v[64:67], v3, s[20:23], 0 offen offset:0
    buffer_load_dwordx4 v[68:71], v3, s[20:23], 0 offen offset:896
    buffer_load_dwordx4 v[72:75], v3, s[20:23], 0 offen offset:1792
    buffer_load_dwordx4 v[76:79], v3, s[20:23], 0 offen offset:2688
    s_mov_b32 s16, 3584
    buffer_load_dwordx4 v[80:83], v3, s[20:23], s16 offen offset:0
    buffer_load_dwordx4 v[84:87], v3, s[20:23], s16 offen offset:896
    buffer_load_dwordx4 v[88:91], v3, s[20:23], s16 offen offset:1792
    buffer_load_dwordx4 v[92:95], v3, s[20:23], s16 offen offset:2688
    v_and_b32 v4, 31, v1
    s_lshl_b32 s14, s12, 9
    s_lshl_b32 s15, s13, 3
    s_add_u32 s14, s14, s15
    s_add_u32 s14, s14, 589824
    v_lshlrev_b32 v5, 4, v4
    buffer_load_dwordx2 v[10:11], v5, s[28:31], s14 offen
    s_lshl_b32 s14, s12, 16
    s_lshl_b32 s15, s13, 10
    s_add_u32 s14, s14, s15
    s_lshl_b32 s15, s11, 7
    s_add_u32 s14, s14, s15
    s_add_u32 s14, s14, 65536
    v_lshlrev_b32 v5, 2, v4
    s_add_u32 s15, s14, 0
    buffer_load_dword v100, v5, s[28:31], s15 offen
    s_add_u32 s15, s14, 2048
    buffer_load_dword v101, v5, s[28:31], s15 offen
    s_add_u32 s15, s14, 4096
    buffer_load_dword v102, v5, s[28:31], s15 offen
    s_add_u32 s15, s14, 6144
    buffer_load_dword v103, v5, s[28:31], s15 offen
    s_add_u32 s15, s14, 8192
    buffer_load_dword v104, v5, s[28:31], s15 offen
    s_add_u32 s15, s14, 10240
    buffer_load_dword v105, v5, s[28:31], s15 offen
    s_add_u32 s15, s14, 12288
    buffer_load_dword v106, v5, s[28:31], s15 offen
    s_add_u32 s15, s14, 14336
    buffer_load_dword v107, v5, s[28:31], s15 offen
    s_add_u32 s15, s14, 16384
    buffer_load_dword v108, v5, s[28:31], s15 offen
    s_add_u32 s15, s14, 18432
    buffer_load_dword v109, v5, s[28:31], s15 offen
    s_add_u32 s15, s14, 20480
    buffer_load_dword v110, v5, s[28:31], s15 offen
    s_add_u32 s15, s14, 22528
    buffer_load_dword v111, v5, s[28:31], s15 offen
    s_add_u32 s15, s14, 24576
    buffer_load_dword v112, v5, s[28:31], s15 offen
    s_add_u32 s15, s14, 26624
    buffer_load_dword v113, v5, s[28:31], s15 offen
    s_add_u32 s15, s14, 28672
    buffer_load_dword v114, v5, s[28:31], s15 offen
    s_add_u32 s15, s14, 30720
    buffer_load_dword v115, v5, s[28:31], s15 offen
    s_add_u32 s15, s14, 32768
    buffer_load_dword v116, v5, s[28:31], s15 offen
    s_add_u32 s15, s14, 34816
    buffer_load_dword v117, v5, s[28:31], s15 offen
    s_add_u32 s15, s14, 36864
    buffer_load_dword v118, v5, s[28:31], s15 offen
    s_add_u32 s15, s14, 38912
    buffer_load_dword v119, v5, s[28:31], s15 offen
    s_add_u32 s15, s14, 40960
    buffer_load_dword v120, v5, s[28:31], s15 offen
    s_add_u32 s15, s14, 43008
    buffer_load_dword v121, v5, s[28:31], s15 offen
    s_add_u32 s15, s14, 45056
    buffer_load_dword v122, v5, s[28:31], s15 offen
    s_add_u32 s15, s14, 47104
    buffer_load_dword v123, v5, s[28:31], s15 offen
    s_add_u32 s15, s14, 49152
    buffer_load_dword v124, v5, s[28:31], s15 offen
    s_add_u32 s15, s14, 51200
    buffer_load_dword v125, v5, s[28:31], s15 offen
    s_add_u32 s15, s14, 53248
    buffer_load_dword v126, v5, s[28:31], s15 offen
    s_add_u32 s15, s14, 55296
    buffer_load_dword v127, v5, s[28:31], s15 offen
    s_add_u32 s15, s14, 57344
    buffer_load_dword v128, v5, s[28:31], s15 offen
    s_add_u32 s15, s14, 59392
    buffer_load_dword v129, v5, s[28:31], s15 offen
    s_add_u32 s15, s14, 61440
    buffer_load_dword v130, v5, s[28:31], s15 offen
    s_add_u32 s15, s14, 63488
    buffer_load_dword v131, v5, s[28:31], s15 offen
    s_waitcnt vmcnt(32)
    v_mov_b32 v12, v10
    s_nop 1
    v_max_f32_dpp v12, v12, v12 row_ror:8 row_mask:0xf bank_mask:0xf
    s_nop 1
    v_max_f32_dpp v12, v12, v12 row_ror:4 row_mask:0xf bank_mask:0xf
    s_nop 1
    v_max_f32_dpp v12, v12, v12 row_ror:2 row_mask:0xf bank_mask:0xf
    s_nop 1
    v_max_f32_dpp v12, v12, v12 row_ror:1 row_mask:0xf bank_mask:0xf
    s_nop 1
    v_readlane_b32 s40, v12, 0
    v_readlane_b32 s41, v12, 16
    s_nop 1
    v_mov_b32 v12, s40
    v_max_f32 v12, s41, v12
    v_sub_f32 v10, v10, v12
    v_mul_f32 v10, 0x3fb8aa3b, v10
    v_exp_f32 v10, v10
    s_nop 0
    v_mul_f32 v11, v10, v11
    s_nop 1
    v_add_f32_dpp v11, v11, v11 row_ror:8 row_mask:0xf bank_mask:0xf
    s_nop 1
    v_add_f32_dpp v11, v11, v11 row_ror:4 row_mask:0xf bank_mask:0xf
    s_nop 1
    v_add_f32_dpp v11, v11, v11 row_ror:2 row_mask:0xf bank_mask:0xf
    s_nop 1
    v_add_f32_dpp v11, v11, v11 row_ror:1 row_mask:0xf bank_mask:0xf
    s_nop 1
    v_readlane_b32 s40, v11, 0
    v_readlane_b32 s41, v11, 16
    s_nop 1
    v_mov_b32 v11, s40
    v_add_f32 v11, s41, v11
    v_rcp_f32 v13, v11
    s_nop 0
    v_mul_f32 v10, v10, v13
    s_lshl_b32 s18, s3, 9
    v_add_u32 v14, s18, v5
    v_cmp_gt_u32 vcc, 32, v1
    s_and_saveexec_b64 s[36:37], vcc
    ds_write_b32 v14, v10
    s_mov_b64 exec, s[36:37]
    s_waitcnt lgkmcnt(0)
    v_mov_b32 v15, s18
    ds_read_b128 v[16:19], v15 offset:0
    ds_read_b128 v[20:23], v15 offset:16
    ds_read_b128 v[24:27], v15 offset:32
    ds_read_b128 v[28:31], v15 offset:48
    ds_read_b128 v[32:35], v15 offset:64
    ds_read_b128 v[36:39], v15 offset:80
    ds_read_b128 v[40:43], v15 offset:96
    ds_read_b128 v[44:47], v15 offset:112
    s_waitcnt vmcnt(0) lgkmcnt(0)
    v_mul_f32 v48, v16, v100
    v_fmac_f32 v48, v17, v101
    v_fmac_f32 v48, v18, v102
    v_fmac_f32 v48, v19, v103
    v_fmac_f32 v48, v20, v104
    v_fmac_f32 v48, v21, v105
    v_fmac_f32 v48, v22, v106
    v_fmac_f32 v48, v23, v107
    v_fmac_f32 v48, v24, v108
    v_fmac_f32 v48, v25, v109
    v_fmac_f32 v48, v26, v110
    v_fmac_f32 v48, v27, v111
    v_fmac_f32 v48, v28, v112
    v_fmac_f32 v48, v29, v113
    v_fmac_f32 v48, v30, v114
    v_fmac_f32 v48, v31, v115
    v_fmac_f32 v48, v32, v116
    v_fmac_f32 v48, v33, v117
    v_fmac_f32 v48, v34, v118
    v_fmac_f32 v48, v35, v119
    v_fmac_f32 v48, v36, v120
    v_fmac_f32 v48, v37, v121
    v_fmac_f32 v48, v38, v122
    v_fmac_f32 v48, v39, v123
    v_fmac_f32 v48, v40, v124
    v_fmac_f32 v48, v41, v125
    v_fmac_f32 v48, v42, v126
    v_fmac_f32 v48, v43, v127
    v_fmac_f32 v48, v44, v128
    v_fmac_f32 v48, v45, v129
    v_fmac_f32 v48, v46, v130
    v_fmac_f32 v48, v47, v131
    v_cvt_pk_bf16_f32 v48, v48, v48
    v_and_b32 v48, 0xffff0000, v48
    s_and_saveexec_b64 s[36:37], vcc
    ds_write_b32 v14, v48 offset:128
    s_mov_b64 exec, s[36:37]
    s_waitcnt lgkmcnt(0)
    s_lshl_b32 s19, s3, 5
    s_add_u32 s19, s19, s18
    v_mov_b32 v15, s19
    ds_read_b128 v[16:19], v15 offset:128
    ds_read_b128 v[20:23], v15 offset:144
    s_waitcnt lgkmcnt(0)
    v_mov_b32 v32, 0
    v_mov_b32 v33, 0
    v_mov_b32 v34, 0
    v_mov_b32 v35, 0
    v_mov_b32 v36, 0
    v_mov_b32 v37, 0
    v_mov_b32 v38, 0
    v_mov_b32 v39, 0
    v_lshlrev_b32 v50, 16, v64
    v_and_b32 v51, 0xffff0000, v64
    v_fmac_f32 v32, v16, v50
    v_fmac_f32 v33, v16, v51
    v_lshlrev_b32 v50, 16, v65
    v_and_b32 v51, 0xffff0000, v65
    v_fmac_f32 v34, v16, v50
    v_fmac_f32 v35, v16, v51
    v_lshlrev_b32 v50, 16, v66
    v_and_b32 v51, 0xffff0000, v66
    v_fmac_f32 v36, v16, v50
    v_fmac_f32 v37, v16, v51
    v_lshlrev_b32 v50, 16, v67
    v_and_b32 v51, 0xffff0000, v67
    v_fmac_f32 v38, v16, v50
    v_fmac_f32 v39, v16, v51
    v_lshlrev_b32 v50, 16, v68
    v_and_b32 v51, 0xffff0000, v68
    v_fmac_f32 v32, v17, v50
    v_fmac_f32 v33, v17, v51
    v_lshlrev_b32 v50, 16, v69
    v_and_b32 v51, 0xffff0000, v69
    v_fmac_f32 v34, v17, v50
    v_fmac_f32 v35, v17, v51
    v_lshlrev_b32 v50, 16, v70
    v_and_b32 v51, 0xffff0000, v70
    v_fmac_f32 v36, v17, v50
    v_fmac_f32 v37, v17, v51
    v_lshlrev_b32 v50, 16, v71
    v_and_b32 v51, 0xffff0000, v71
    v_fmac_f32 v38, v17, v50
    v_fmac_f32 v39, v17, v51
    v_lshlrev_b32 v50, 16, v72
    v_and_b32 v51, 0xffff0000, v72
    v_fmac_f32 v32, v18, v50
    v_fmac_f32 v33, v18, v51
    v_lshlrev_b32 v50, 16, v73
    v_and_b32 v51, 0xffff0000, v73
    v_fmac_f32 v34, v18, v50
    v_fmac_f32 v35, v18, v51
    v_lshlrev_b32 v50, 16, v74
    v_and_b32 v51, 0xffff0000, v74
    v_fmac_f32 v36, v18, v50
    v_fmac_f32 v37, v18, v51
    v_lshlrev_b32 v50, 16, v75
    v_and_b32 v51, 0xffff0000, v75
    v_fmac_f32 v38, v18, v50
    v_fmac_f32 v39, v18, v51
    v_lshlrev_b32 v50, 16, v76
    v_and_b32 v51, 0xffff0000, v76
    v_fmac_f32 v32, v19, v50
    v_fmac_f32 v33, v19, v51
    v_lshlrev_b32 v50, 16, v77
    v_and_b32 v51, 0xffff0000, v77
    v_fmac_f32 v34, v19, v50
    v_fmac_f32 v35, v19, v51
    v_lshlrev_b32 v50, 16, v78
    v_and_b32 v51, 0xffff0000, v78
    v_fmac_f32 v36, v19, v50
    v_fmac_f32 v37, v19, v51
    v_lshlrev_b32 v50, 16, v79
    v_and_b32 v51, 0xffff0000, v79
    v_fmac_f32 v38, v19, v50
    v_fmac_f32 v39, v19, v51
    v_lshlrev_b32 v50, 16, v80
    v_and_b32 v51, 0xffff0000, v80
    v_fmac_f32 v32, v20, v50
    v_fmac_f32 v33, v20, v51
    v_lshlrev_b32 v50, 16, v81
    v_and_b32 v51, 0xffff0000, v81
    v_fmac_f32 v34, v20, v50
    v_fmac_f32 v35, v20, v51
    v_lshlrev_b32 v50, 16, v82
    v_and_b32 v51, 0xffff0000, v82
    v_fmac_f32 v36, v20, v50
    v_fmac_f32 v37, v20, v51
    v_lshlrev_b32 v50, 16, v83
    v_and_b32 v51, 0xffff0000, v83
    v_fmac_f32 v38, v20, v50
    v_fmac_f32 v39, v20, v51
    v_lshlrev_b32 v50, 16, v84
    v_and_b32 v51, 0xffff0000, v84
    v_fmac_f32 v32, v21, v50
    v_fmac_f32 v33, v21, v51
    v_lshlrev_b32 v50, 16, v85
    v_and_b32 v51, 0xffff0000, v85
    v_fmac_f32 v34, v21, v50
    v_fmac_f32 v35, v21, v51
    v_lshlrev_b32 v50, 16, v86
    v_and_b32 v51, 0xffff0000, v86
    v_fmac_f32 v36, v21, v50
    v_fmac_f32 v37, v21, v51
    v_lshlrev_b32 v50, 16, v87
    v_and_b32 v51, 0xffff0000, v87
    v_fmac_f32 v38, v21, v50
    v_fmac_f32 v39, v21, v51
    v_lshlrev_b32 v50, 16, v88
    v_and_b32 v51, 0xffff0000, v88
    v_fmac_f32 v32, v22, v50
    v_fmac_f32 v33, v22, v51
    v_lshlrev_b32 v50, 16, v89
    v_and_b32 v51, 0xffff0000, v89
    v_fmac_f32 v34, v22, v50
    v_fmac_f32 v35, v22, v51
    v_lshlrev_b32 v50, 16, v90
    v_and_b32 v51, 0xffff0000, v90
    v_fmac_f32 v36, v22, v50
    v_fmac_f32 v37, v22, v51
    v_lshlrev_b32 v50, 16, v91
    v_and_b32 v51, 0xffff0000, v91
    v_fmac_f32 v38, v22, v50
    v_fmac_f32 v39, v22, v51
    v_lshlrev_b32 v50, 16, v92
    v_and_b32 v51, 0xffff0000, v92
    v_fmac_f32 v32, v23, v50
    v_fmac_f32 v33, v23, v51
    v_lshlrev_b32 v50, 16, v93
    v_and_b32 v51, 0xffff0000, v93
    v_fmac_f32 v34, v23, v50
    v_fmac_f32 v35, v23, v51
    v_lshlrev_b32 v50, 16, v94
    v_and_b32 v51, 0xffff0000, v94
    v_fmac_f32 v36, v23, v50
    v_fmac_f32 v37, v23, v51
    v_lshlrev_b32 v50, 16, v95
    v_and_b32 v51, 0xffff0000, v95
    v_fmac_f32 v38, v23, v50
    v_fmac_f32 v39, v23, v51
    s_mul_i32 s18, s3, 1792
    v_lshlrev_b32 v14, 5, v1
    v_add_u32 v14, s18, v14
    v_cmp_gt_u32 vcc, 56, v1
    s_and_saveexec_b64 s[36:37], vcc
    ds_write_b128 v14, v[32:35] offset:2048
    ds_write_b128 v14, v[36:39] offset:2064
    s_mov_b64 exec, s[36:37]
    s_waitcnt lgkmcnt(0)
    s_barrier
    v_cmp_gt_u32 vcc, 224, v0
    s_and_saveexec_b64 s[36:37], vcc
    s_cbranch_execz K3_DONE
    v_lshlrev_b32 v14, 3, v0
    ds_read_b64 v[16:17], v14 offset:2048
    ds_read_b64 v[18:19], v14 offset:3840
    ds_read_b64 v[20:21], v14 offset:5632
    ds_read_b64 v[22:23], v14 offset:7424
    s_waitcnt lgkmcnt(0)
    v_add_f32 v16, v16, v18
    v_add_f32 v17, v17, v19
    v_add_f32 v16, v16, v20
    v_add_f32 v17, v17, v21
    v_add_f32 v16, v16, v22
    v_add_f32 v17, v17, v23
    s_mul_i32 s18, s2, 1792
    s_add_u32 s18, s18, 1048576
    buffer_store_dwordx2 v[16:17], v14, s[28:31], s18 offen
K3_DONE:
    s_mov_b64 exec, s[36:37]
K3_END:
    s_endpgm
.globl k4_kernel
.p2align 8
.type k4_kernel,@function
k4_kernel:
    s_cmp_ge_u32 s2, 7
    s_cbranch_scc1 K4_END
    s_load_dwordx2 s[4:5], s[0:1], 0
    s_load_dwordx2 s[6:7], s[0:1], 80
    s_load_dwordx2 s[8:9], s[0:1], 96
    v_and_b32 v1, 63, v0
    v_lshrrev_b32 v2, 6, v0
    s_waitcnt lgkmcnt(0)
    s_mov_b32 s20, s4
    s_and_b32 s21, s5, 0xffff
    s_mov_b32 s22, 896
    s_mov_b32 s23, 0x00020000
    s_mov_b32 s24, s6
    s_and_b32 s25, s7, 0xffff
    s_mov_b32 s26, 896
    s_mov_b32 s27, 0x00020000
    s_mov_b32 s28, s8
    s_and_b32 s29, s9, 0xffff
    s_mov_b32 s30, 536870912
    s_mov_b32 s31, 0x00020000
    s_lshl_b32 s10, s2, 6
    v_add_u32 v3, s10, v1
    v_lshlrev_b32 v4, 2, v3
    v_mul_u32_u24 v5, 57344, v2
    v_add_u32 v5, v5, v4
    s_mov_b32 s11, 1048576
    buffer_load_dword v16, v5, s[28:31], s11 offen
    s_mov_b32 s11, 1050368
    buffer_load_dword v17, v5, s[28:31], s11 offen
    s_mov_b32 s11, 1052160
    buffer_load_dword v18, v5, s[28:31], s11 offen
    s_mov_b32 s11, 1053952
    buffer_load_dword v19, v5, s[28:31], s11 offen
    s_mov_b32 s11, 1055744
    buffer_load_dword v20, v5, s[28:31], s11 offen
    s_mov_b32 s11, 1057536
    buffer_load_dword v21, v5, s[28:31], s11 offen
    s_mov_b32 s11, 1059328
    buffer_load_dword v22, v5, s[28:31], s11 offen
    s_mov_b32 s11, 1061120
    buffer_load_dword v23, v5, s[28:31], s11 offen
    s_mov_b32 s11, 1062912
    buffer_load_dword v24, v5, s[28:31], s11 offen
    s_mov_b32 s11, 1064704
    buffer_load_dword v25, v5, s[28:31], s11 offen
    s_mov_b32 s11, 1066496
    buffer_load_dword v26, v5, s[28:31], s11 offen
    s_mov_b32 s11, 1068288
    buffer_load_dword v27, v5, s[28:31], s11 offen
    s_mov_b32 s11, 1070080
    buffer_load_dword v28, v5, s[28:31], s11 offen
    s_mov_b32 s11, 1071872
    buffer_load_dword v29, v5, s[28:31], s11 offen
    s_mov_b32 s11, 1073664
    buffer_load_dword v30, v5, s[28:31], s11 offen
    s_mov_b32 s11, 1075456
    buffer_load_dword v31, v5, s[28:31], s11 offen
    s_mov_b32 s11, 1077248
    buffer_load_dword v32, v5, s[28:31], s11 offen
    s_mov_b32 s11, 1079040
    buffer_load_dword v33, v5, s[28:31], s11 offen
    s_mov_b32 s11, 1080832
    buffer_load_dword v34, v5, s[28:31], s11 offen
    s_mov_b32 s11, 1082624
    buffer_load_dword v35, v5, s[28:31], s11 offen
    s_mov_b32 s11, 1084416
    buffer_load_dword v36, v5, s[28:31], s11 offen
    s_mov_b32 s11, 1086208
    buffer_load_dword v37, v5, s[28:31], s11 offen
    s_mov_b32 s11, 1088000
    buffer_load_dword v38, v5, s[28:31], s11 offen
    s_mov_b32 s11, 1089792
    buffer_load_dword v39, v5, s[28:31], s11 offen
    s_mov_b32 s11, 1091584
    buffer_load_dword v40, v5, s[28:31], s11 offen
    s_mov_b32 s11, 1093376
    buffer_load_dword v41, v5, s[28:31], s11 offen
    s_mov_b32 s11, 1095168
    buffer_load_dword v42, v5, s[28:31], s11 offen
    s_mov_b32 s11, 1096960
    buffer_load_dword v43, v5, s[28:31], s11 offen
    s_mov_b32 s11, 1098752
    buffer_load_dword v44, v5, s[28:31], s11 offen
    s_mov_b32 s11, 1100544
    buffer_load_dword v45, v5, s[28:31], s11 offen
    s_mov_b32 s11, 1102336
    buffer_load_dword v46, v5, s[28:31], s11 offen
    s_mov_b32 s11, 1104128
    buffer_load_dword v47, v5, s[28:31], s11 offen
    v_lshlrev_b32 v6, 1, v3
    buffer_load_ushort v8, v6, s[20:23], 0 offen
    s_mov_b32 s11, 16384
    buffer_load_dword v9, v4, s[28:31], s11 offen
    s_waitcnt vmcnt(0)
    v_add_f32 v16, v16, v17
    v_add_f32 v16, v16, v18
    v_add_f32 v16, v16, v19
    v_add_f32 v16, v16, v20
    v_add_f32 v16, v16, v21
    v_add_f32 v16, v16, v22
    v_add_f32 v16, v16, v23
    v_add_f32 v16, v16, v24
    v_add_f32 v16, v16, v25
    v_add_f32 v16, v16, v26
    v_add_f32 v16, v16, v27
    v_add_f32 v16, v16, v28
    v_add_f32 v16, v16, v29
    v_add_f32 v16, v16, v30
    v_add_f32 v16, v16, v31
    v_add_f32 v16, v16, v32
    v_add_f32 v16, v16, v33
    v_add_f32 v16, v16, v34
    v_add_f32 v16, v16, v35
    v_add_f32 v16, v16, v36
    v_add_f32 v16, v16, v37
    v_add_f32 v16, v16, v38
    v_add_f32 v16, v16, v39
    v_add_f32 v16, v16, v40
    v_add_f32 v16, v16, v41
    v_add_f32 v16, v16, v42
    v_add_f32 v16, v16, v43
    v_add_f32 v16, v16, v44
    v_add_f32 v16, v16, v45
    v_add_f32 v16, v16, v46
    v_add_f32 v16, v16, v47
    v_lshlrev_b32 v7, 2, v0
    ds_write_b32 v7, v16
    s_waitcnt lgkmcnt(0)
    s_barrier
    v_cmp_gt_u32 vcc, 64, v0
    s_and_saveexec_b64 s[36:37], vcc
    s_cbranch_execz K4_DONE
    ds_read_b32 v50, v7 offset:0
    ds_read_b32 v51, v7 offset:256
    ds_read_b32 v52, v7 offset:512
    ds_read_b32 v53, v7 offset:768
    s_waitcnt lgkmcnt(0)
    v_add_f32 v50, v50, v51
    v_add_f32 v52, v52, v53
    v_add_f32 v50, v50, v52
    v_cvt_pk_bf16_f32 v50, v50, v50
    v_and_b32 v50, 0xffff0000, v50
    v_lshlrev_b32 v8, 16, v8
    v_add_f32 v50, v8, v50
    v_cvt_pk_bf16_f32 v50, v50, v50
    v_and_b32 v50, 0xffff0000, v50
    v_add_f32 v50, v50, v9
    v_cvt_pk_bf16_f32 v50, v50, v50
    buffer_store_short v50, v6, s[24:27], 0 offen
K4_DONE:
    s_mov_b64 exec, s[36:37]
K4_END:
    s_endpgm
.section .rodata,"a"
.p2align 6
.amdhsa_kernel k1_kernel
  .amdhsa_next_free_vgpr 96
  .amdhsa_next_free_sgpr 102
  .amdhsa_accum_offset 96
  .amdhsa_group_segment_fixed_size 0
  .amdhsa_kernarg_size 104
  .amdhsa_user_sgpr_count 2
  .amdhsa_user_sgpr_kernarg_segment_ptr 1
  .amdhsa_system_sgpr_workgroup_id_x 1
.end_amdhsa_kernel
.p2align 6
.amdhsa_kernel k2_kernel
  .amdhsa_next_free_vgpr 248
  .amdhsa_next_free_sgpr 102
  .amdhsa_accum_offset 248
  .amdhsa_group_segment_fixed_size 0
  .amdhsa_kernarg_size 104
  .amdhsa_user_sgpr_count 2
  .amdhsa_user_sgpr_kernarg_segment_ptr 1
  .amdhsa_system_sgpr_workgroup_id_x 1
.end_amdhsa_kernel
.p2align 6
.amdhsa_kernel k3_kernel
  .amdhsa_next_free_vgpr 136
  .amdhsa_next_free_sgpr 102
  .amdhsa_accum_offset 136
  .amdhsa_group_segment_fixed_size 0
  .amdhsa_kernarg_size 104
  .amdhsa_user_sgpr_count 2
  .amdhsa_user_sgpr_kernarg_segment_ptr 1
  .amdhsa_system_sgpr_workgroup_id_x 1
.end_amdhsa_kernel
.p2align 6
.amdhsa_kernel k4_kernel
  .amdhsa_next_free_vgpr 64
  .amdhsa_next_free_sgpr 102
  .amdhsa_accum_offset 64
  .amdhsa_group_segment_fixed_size 0
  .amdhsa_kernarg_size 104
  .amdhsa_user_sgpr_count 2
  .amdhsa_user_sgpr_kernarg_segment_ptr 1
  .amdhsa_system_sgpr_workgroup_id_x 1
.end_amdhsa_kernel
```
